```python
import torch

def _softmax(x, axis=-1):
    return torch.softmax(x, dim=axis)
def _gelu(x):
    return torch.nn.functional.gelu(x, approximate="tanh")
def _silu(x):
    return torch.nn.functional.silu(x)
def _sigmoid(x):
    return torch.sigmoid(x)
def _layernorm(x, axis=-1, eps=1e-5):
    m = x.mean(dim=axis, keepdim=True)
    v = x.var(dim=axis, keepdim=True, unbiased=False)
    return (x - m) / torch.sqrt(v + eps)
def _scatter_add(tgt, idx, src, axis=0):
    return tgt.clone().index_add_(axis, idx, src)
def _segment_sum(src, seg, n):
    out = torch.zeros((n,) + src.shape[1:], dtype=src.dtype)
    return out.index_add_(0, seg, src)
def _pad(x, pw):
    flat = tuple(v for pair in reversed(pw) for v in pair)
    return torch.nn.functional.pad(x, flat)

kernel_name = 'standalone__edge_featured_mpnn_mpnn__graph'

def setup_inputs():

    _w = (lambda a: (lambda t: t.to(torch.bfloat16) if t.is_floating_point() else t)(torch.as_tensor(a)))
    N, deg, D, De = 50000, 16, 64, max(16, 1)
    E = N * deg
    H = 2 * D
    return {
        "x": _w((lambda *s: torch.randn(*s, dtype=torch.bfloat16) * 0.05)(N, D)),
        "e_attr": _w((lambda *s: torch.randn(*s, dtype=torch.bfloat16) * 0.8)(E, De)),
        "src": _w((lambda lo, hi, *s: torch.randint(lo, hi, s))(0, N, E).to(torch.int64)),
        "dst": _w((lambda lo, hi, *s: torch.randint(lo, hi, s))(0, N, E).to(torch.int64)),
        "w1": _w((lambda *s: torch.randn(*s, dtype=torch.bfloat16) * 0.8)(2 * D + De, H) * (1.0 / (2 * D + De) ** 0.5)),
        "b1": _w((lambda *s: torch.randn(*s, dtype=torch.bfloat16) * 0.8)(H) * 0.01),
        "w2": _w((lambda *s: torch.randn(*s, dtype=torch.bfloat16) * 0.05)(H, D) * (1.0 / H ** 0.5)),
        "b2": _w((lambda *s: torch.randn(*s, dtype=torch.bfloat16) * 0.05)(D) * 0.01),
    }

def reference(x, e_attr, src, dst, w1, b1, w2, b2):
    N, D = x.shape
    h_src = x[src]
    h_dst = x[dst]
    m_in = torch.concatenate([h_src, h_dst, e_attr], axis=-1)
    h = _silu(m_in @ w1 + b1)
    msg = h @ w2 + b2
    return _segment_sum(msg, dst, N)
```

```asm
; @launch grid=(256,1,1) block=(256,1,1) lds=163840
.amdgcn_target "amdgcn-amd-amdhsa--gfx950"
.text
.globl standalone__edge_featured_mpnn_mpnn__graph_kernel
.type standalone__edge_featured_mpnn_mpnn__graph_kernel,@function
.p2align 8
standalone__edge_featured_mpnn_mpnn__graph_kernel:
    s_cmp_ge_u32 s2, 256
    s_cbranch_scc1 L_end
    s_load_dwordx8 s[4:11], s[0:1], 0
    s_load_dwordx4 s[60:63], s[0:1], 64
    s_load_dwordx2 s[64:65], s[0:1], 80
    s_load_dwordx8 s[52:59], s[0:1], 32
    s_memrealtime s[82:83]
    s_getpc_b64 s[14:15]
L_pc:
    v_lshlrev_b32 v15, 2, v0
    v_min_u32 v3, 4, v0
    s_lshr_b32 s3, s2, 3
    v_lshl_add_u32 v3, v3, 5, s3
    v_lshlrev_b32 v3, 7, v3
    v_min_u32 v3, L_slow0-L_pc, v3
    global_load_dword a228, v3, s[14:15]
    s_add_u32 s14, s14, L_table-L_pc
    s_addc_u32 s15, s15, 0
    s_xor_b32 s85, s2, 0
    s_and_b32 s85, s85, 1
    v_lshl_add_u32 v3, s85, 10, v15
    global_load_dword v11, v3, s[14:15]
    v_lshrrev_b32 v1, 6, v0
    v_and_b32 v2, 63, v0
    v_readfirstlane_b32 s31, v1
    v_lshlrev_b32 v21, 4, v0
    v_mov_b32 v4, 0
    v_mov_b32 v5, 0
    v_mov_b32 v6, 0
    v_mov_b32 v7, 0
    ds_write_b128 v21, v[4:7]
    v_lshlrev_b32 v3, 3, v0
    ds_write_b64 v3, v[4:5] offset:4096
    v_mov_b32 v12, 0
    v_mov_b32 v13, 1
    v_lshlrev_b32 v9, 4, v2
    v_cmp_gt_u32 vcc, 53, v0
    s_mul_i32 s3, s2, 12500
    s_mov_b32 s70, 3200000
    s_mov_b32 s71, 0x20000
    s_mov_b32 s74, 3200000
    s_mov_b32 s75, 0x20000
    s_mov_b64 s[76:77], vcc
    s_mov_b32 s66, 0
    s_waitcnt lgkmcnt(0)
    s_mov_b32 s68, s10
    s_and_b32 s69, s11, 0xffff
    s_mov_b32 s72, s8
    s_and_b32 s73, s9, 0xffff
    s_add_u32 s8, s3, 0
    s_add_u32 s9, s3, 4096
    s_add_u32 s10, s3, 8192
    s_add_u32 s11, s3, 12288
    s_lshr_b32 s37, s2, 3
    s_or_b32 s37, s37, s31
    s_cbranch_scc1 L_notag
    s_or_b32 s82, s82, 1
    v_mov_b32 v4, s82
    v_mov_b32 v5, s83
    s_mov_b64 exec, 1
    global_atomic_cmpswap_x2 v12, v[4:7], s[62:63] sc1
    s_mov_b64 exec, -1
L_notag:
    buffer_load_dwordx4 v[32:35], v21, s[68:71], s8 offen nt
    buffer_load_dwordx4 v[36:39], v21, s[68:71], s9 offen nt
    buffer_load_dwordx4 v[40:43], v21, s[68:71], s10 offen nt
    buffer_load_dword v44, v15, s[68:71], s11 offen nt
    v_and_b32 v10, 3, v0
    v_bfe_u32 v16, v0, 2, 4
    v_lshl_add_u32 v10, v16, 3, v10
    v_lshl_add_u32 v10, v1, 2, v10
    v_lshrrev_b32 v16, 1, v0
    v_and_b32 v16, 32, v16
    v_xor_b32 v16, v16, v2
    s_cmp_lt_u32 s31, 2
    s_cselect_b64 vcc, -1, 0
    v_cndmask_b32 v10, v16, v10, vcc
    v_lshlrev_b32 v10, 1, v10
    s_cselect_b64 s[54:55], s[54:55], s[58:59]
    s_cselect_b32 s34, 3216550459, 1.0
    global_load_ushort v10, v10, s[54:55]
    v_mov_b32 v128, 1073807359
    v_mov_b32 v129, 1073807359
    v_mov_b32 v130, 1073807359
    v_mov_b32 v131, 1073807359
    v_add_u32 v132, 24576, v21
    s_movk_i32 s38, 201
    s_bfe_u32 s28, s2, 0x20001
    s_lshl_b32 s28, s28, 5
    s_lshr_b32 s3, s2, 3
    s_add_u32 s28, s28, s3
    s_bitcmp1_b32 s2, 0
    s_cselect_b32 s59, 190, s38
    s_cselect_b32 s3, 25728, 0
    s_cselect_b32 s35, 128, 0
    s_mul_i32 s29, s28, s59
    s_add_u32 s29, s29, s3
    s_add_u32 s28, s28, s35
    s_sub_u32 s30, 50000, s29
    s_min_u32 s30, s30, s59
    s_lshl_b32 s33, s28, 3
    s_add_u32 s33, s33, 8388608
    ds_write_b128 v132, v[128:131] offset:61440
    s_sub_u32 s12, s4, 3168
    s_subb_u32 s13, s5, 0
    s_and_b32 s13, s13, 0xffff
    s_mov_b32 s14, 6403168
    s_mov_b32 s15, 0x20000
    s_mov_b32 s16, s6
    ds_write_b128 v132, v[128:131] offset:57344
    s_and_b32 s17, s7, 0xffff
    s_mov_b32 s18, 25600000
    s_mov_b32 s19, 0x20000
    s_mov_b32 s24, s60
    s_and_b32 s25, s61, 0xffff
    s_mov_b32 s26, 6400000
    ds_write_b128 v132, v[128:131] offset:53248
    s_mov_b32 s27, 0x20000
    s_mov_b32 s20, s64
    s_and_b32 s21, s65, 0xffff
    s_mov_b32 s22, 10485760
    s_mov_b32 s23, 0x20000
    s_movk_i32 s36, 3168
    ds_write_b128 v132, v[128:131] offset:49152
    s_movk_i32 s37, 2112
    s_movk_i32 s38, 1056
    s_movk_i32 s39, 0
    s_movk_i32 s40, 128
    s_mov_b32 s48, 3207688728
    s_mov_b32 s49, 3207688728
    ds_write_b128 v132, v[128:131] offset:45056
    s_mov_b64 s[50:51], 0
    s_lshl_b32 s32, s31, 12
    s_add_u32 s32, s32, 73728
    s_lshl_b32 s47, s31, 13
    s_add_u32 s47, s47, 8192
    s_mul_i32 s41, s31, 10496
    ds_write_b128 v132, v[128:131] offset:40960
    s_add_u32 s41, s41, 73728
    v_and_b32 v16, 7, v2
    v_lshrrev_b32 v18, 5, v2
    v_xor_b32 v16, v16, v18
    v_lshlrev_b32 v245, 4, v16
    v_and_b32 v17, 1, v2
    ds_write_b128 v132, v[128:131] offset:36864
    v_lshlrev_b32 v248, 4, v17
    v_bfe_u32 v16, v2, 1, 2
    v_mul_u32_u24 v16, 1056, v16
    v_bfe_u32 v20, v2, 3, 2
    v_lshl_add_u32 v16, v20, 7, v16
    v_lshl_add_u32 v16, v17, 9, v16
    ds_write_b128 v132, v[128:131] offset:32768
    v_xor_b32 v20, v17, v18
    v_lshl_add_u32 v249, v20, 4, v16
    v_bfe_u32 v16, v2, 1, 4
    v_lshl_add_u32 v16, v17, 4, v16
    v_lshlrev_b32 v16, 5, v16
    v_lshl_add_u32 v16, v18, 4, v16
    buffer_load_dwordx4 v[48:51], v21, s[72:75], s8 offen nt
    buffer_load_dwordx4 v[52:55], v21, s[72:75], s9 offen nt
    buffer_load_dwordx4 v[56:59], v21, s[72:75], s10 offen nt
    buffer_load_dword v60, v15, s[72:75], s11 offen nt
    s_mov_b32 s68, s52
    s_and_b32 s69, s53, 0xffff
    s_mov_b32 s70, 36864
    s_mov_b32 s71, 0x20000
    s_mov_b32 s72, s56
    s_and_b32 s73, s57, 0xffff
    s_mov_b32 s74, 16384
    s_mov_b32 s75, 0x20000
    s_lshr_b32 s3, s2, 3
    v_min_u32 v3, 8, v0
    v_lshl_add_u32 v3, v3, 5, s3
    v_lshlrev_b32 v3, 7, v3
    buffer_load_dword a228, v3, s[68:71], 0 offen
    buffer_load_dword a228, v3, s[72:75], 0 offen
    ds_write_b128 v132, v[128:131] offset:28672
    v_add_u32 v250, 4224, v16
    v_lshrrev_b32 v16, 3, v2
    v_lshl_add_u32 v246, v16, 4, s47
    v_lshrrev_b32 v16, 1, v2
    v_lshl_add_u32 v247, v16, 2, s47
    v_and_b32 v16, 31, v2
    ds_write_b128 v132, v[128:131] offset:24576
    v_lshlrev_b32 v16, 2, v16
    v_lshl_add_u32 v16, v18, 12, v16
    v_add_u32 v25, s47, v16
    v_add_u32 v24, s29, v0
    v_cmp_gt_u32 s[78:79], s59, v0
    v_cmp_gt_u32 s[80:81], s30, v0
    ds_write_b128 v132, v[128:131] offset:20480
    v_and_b32 v134, 255, v24
    v_lshlrev_b32 v134, 4, v134
    s_add_u32 s3, s29, 240
    s_and_b32 s3, s3, 255
    s_lshl_b32 s3, s3, 4
    v_mov_b32 v135, s3
    ds_write_b128 v132, v[128:131] offset:16384
    v_lshlrev_b32 v19, 2, v2
    v_lshlrev_b32 v14, 3, v2
    v_mul_u32_u24 v30, 2304, v0
    v_and_b32 v31, 31, v0
    v_lshlrev_b32 v31, 4, v31
    v_lshl_add_u32 v31, v0, 12, v31
    ds_write_b128 v132, v[128:131] offset:12288
    s_mov_b32 s55, 83469
    s_movk_i32 s56, 4833
    s_movk_i32 s57, 335
    v_mov_b32 v23, 25728
    s_mov_b32 s58, 786432
    s_waitcnt lgkmcnt(0)
    s_barrier
    s_waitcnt vmcnt(10)
    v_mul_u32_u24 v64, s55, v32
    v_mul_u32_u24 v65, s55, v33
    v_mul_u32_u24 v66, s55, v34
    v_mul_u32_u24 v67, s55, v35
    v_sub_u32_e64 v80, v32, v23 clamp
    v_sub_u32_e64 v81, v33, v23 clamp
    v_sub_u32_e64 v82, v34, v23 clamp
    v_sub_u32_e64 v83, v35, v23 clamp
    v_mad_u32_u24 v64, v80, s56, v64
    v_mad_u32_u24 v65, v81, s56, v65
    v_mad_u32_u24 v66, v82, s56, v66
    v_mad_u32_u24 v67, v83, s56, v67
    v_lshlrev_b32_sdwa v64, 2, v64 dst_sel:DWORD dst_unused:UNUSED_PAD src0_sel:DWORD src1_sel:BYTE_3
    v_lshlrev_b32_sdwa v65, 2, v65 dst_sel:DWORD dst_unused:UNUSED_PAD src0_sel:DWORD src1_sel:BYTE_3
    v_lshlrev_b32_sdwa v66, 2, v66 dst_sel:DWORD dst_unused:UNUSED_PAD src0_sel:DWORD src1_sel:BYTE_3
    v_lshlrev_b32_sdwa v67, 2, v67 dst_sel:DWORD dst_unused:UNUSED_PAD src0_sel:DWORD src1_sel:BYTE_3
    ds_add_rtn_u32 v80, v64, v13 offset:4096
    ds_add_rtn_u32 v81, v65, v13 offset:4096
    ds_add_rtn_u32 v82, v66, v13 offset:4096
    ds_add_rtn_u32 v83, v67, v13 offset:4096
    s_waitcnt vmcnt(9)
    v_mul_u32_u24 v68, s55, v36
    v_mul_u32_u24 v69, s55, v37
    v_mul_u32_u24 v70, s55, v38
    v_mul_u32_u24 v71, s55, v39
    v_sub_u32_e64 v84, v36, v23 clamp
    v_sub_u32_e64 v85, v37, v23 clamp
    v_sub_u32_e64 v86, v38, v23 clamp
    v_sub_u32_e64 v87, v39, v23 clamp
    v_mad_u32_u24 v68, v84, s56, v68
    v_mad_u32_u24 v69, v85, s56, v69
    v_mad_u32_u24 v70, v86, s56, v70
    v_mad_u32_u24 v71, v87, s56, v71
    v_lshlrev_b32_sdwa v68, 2, v68 dst_sel:DWORD dst_unused:UNUSED_PAD src0_sel:DWORD src1_sel:BYTE_3
    v_lshlrev_b32_sdwa v69, 2, v69 dst_sel:DWORD dst_unused:UNUSED_PAD src0_sel:DWORD src1_sel:BYTE_3
    v_lshlrev_b32_sdwa v70, 2, v70 dst_sel:DWORD dst_unused:UNUSED_PAD src0_sel:DWORD src1_sel:BYTE_3
    v_lshlrev_b32_sdwa v71, 2, v71 dst_sel:DWORD dst_unused:UNUSED_PAD src0_sel:DWORD src1_sel:BYTE_3
    ds_add_rtn_u32 v84, v68, v13 offset:4096
    ds_add_rtn_u32 v85, v69, v13 offset:4096
    ds_add_rtn_u32 v86, v70, v13 offset:4096
    ds_add_rtn_u32 v87, v71, v13 offset:4096
    s_waitcnt vmcnt(7)
    global_load_dwordx2 v[122:123], v12, s[62:63] sc1
    v_mul_u32_u24 v72, s55, v40
    v_mul_u32_u24 v73, s55, v41
    v_mul_u32_u24 v74, s55, v42
    v_mul_u32_u24 v75, s55, v43
    v_mul_u32_u24 v76, s55, v44
    v_sub_u32_e64 v88, v40, v23 clamp
    v_sub_u32_e64 v89, v41, v23 clamp
    v_sub_u32_e64 v90, v42, v23 clamp
    v_sub_u32_e64 v91, v43, v23 clamp
    v_sub_u32_e64 v92, v44, v23 clamp
    v_mad_u32_u24 v72, v88, s56, v72
    v_mad_u32_u24 v73, v89, s56, v73
    v_mad_u32_u24 v74, v90, s56, v74
    v_mad_u32_u24 v75, v91, s56, v75
    v_mad_u32_u24 v76, v92, s56, v76
    v_lshlrev_b32_sdwa v72, 2, v72 dst_sel:DWORD dst_unused:UNUSED_PAD src0_sel:DWORD src1_sel:BYTE_3
    v_lshlrev_b32_sdwa v73, 2, v73 dst_sel:DWORD dst_unused:UNUSED_PAD src0_sel:DWORD src1_sel:BYTE_3
    v_lshlrev_b32_sdwa v74, 2, v74 dst_sel:DWORD dst_unused:UNUSED_PAD src0_sel:DWORD src1_sel:BYTE_3
    v_lshlrev_b32_sdwa v75, 2, v75 dst_sel:DWORD dst_unused:UNUSED_PAD src0_sel:DWORD src1_sel:BYTE_3
    v_lshlrev_b32_sdwa v76, 2, v76 dst_sel:DWORD dst_unused:UNUSED_PAD src0_sel:DWORD src1_sel:BYTE_3
    ds_add_rtn_u32 v88, v72, v13 offset:4096
    ds_add_rtn_u32 v89, v73, v13 offset:4096
    ds_add_rtn_u32 v90, v74, v13 offset:4096
    ds_add_rtn_u32 v91, v75, v13 offset:4096
    s_mov_b64 exec, s[76:77]
    ds_add_rtn_u32 v92, v76, v13 offset:4096
    s_mov_b64 exec, -1
    v_lshlrev_b32_sdwa v32, 20, v32 dst_sel:DWORD dst_unused:UNUSED_PAD src0_sel:DWORD src1_sel:BYTE_0
    v_lshlrev_b32_sdwa v33, 20, v33 dst_sel:DWORD dst_unused:UNUSED_PAD src0_sel:DWORD src1_sel:BYTE_0
    v_lshlrev_b32_sdwa v34, 20, v34 dst_sel:DWORD dst_unused:UNUSED_PAD src0_sel:DWORD src1_sel:BYTE_0
    v_lshlrev_b32_sdwa v35, 20, v35 dst_sel:DWORD dst_unused:UNUSED_PAD src0_sel:DWORD src1_sel:BYTE_0
    v_lshlrev_b32_sdwa v36, 20, v36 dst_sel:DWORD dst_unused:UNUSED_PAD src0_sel:DWORD src1_sel:BYTE_0
    v_lshlrev_b32_sdwa v37, 20, v37 dst_sel:DWORD dst_unused:UNUSED_PAD src0_sel:DWORD src1_sel:BYTE_0
    v_lshlrev_b32_sdwa v38, 20, v38 dst_sel:DWORD dst_unused:UNUSED_PAD src0_sel:DWORD src1_sel:BYTE_0
    v_lshlrev_b32_sdwa v39, 20, v39 dst_sel:DWORD dst_unused:UNUSED_PAD src0_sel:DWORD src1_sel:BYTE_0
    v_lshlrev_b32_sdwa v40, 20, v40 dst_sel:DWORD dst_unused:UNUSED_PAD src0_sel:DWORD src1_sel:BYTE_0
    v_lshlrev_b32_sdwa v41, 20, v41 dst_sel:DWORD dst_unused:UNUSED_PAD src0_sel:DWORD src1_sel:BYTE_0
    v_lshlrev_b32_sdwa v42, 20, v42 dst_sel:DWORD dst_unused:UNUSED_PAD src0_sel:DWORD src1_sel:BYTE_0
    v_lshlrev_b32_sdwa v43, 20, v43 dst_sel:DWORD dst_unused:UNUSED_PAD src0_sel:DWORD src1_sel:BYTE_0
    v_lshlrev_b32_sdwa v44, 20, v44 dst_sel:DWORD dst_unused:UNUSED_PAD src0_sel:DWORD src1_sel:BYTE_0
    s_mov_b32 s35, 0
    buffer_load_dwordx4 v[144:147], v21, s[68:71], s35 offen
    s_add_u32 s35, s35, 4096
    buffer_load_dwordx4 v[148:151], v21, s[68:71], s35 offen
    s_add_u32 s35, s35, 4096
    buffer_load_dwordx4 v[152:155], v21, s[68:71], s35 offen
    s_add_u32 s35, s35, 4096
    buffer_load_dwordx4 v[156:159], v21, s[68:71], s35 offen
    s_add_u32 s35, s35, 4096
    s_waitcnt lgkmcnt(0)
    s_barrier
    ds_read_b128 v[26:29], v9 offset:4096
    s_waitcnt vmcnt(7) lgkmcnt(0)
    v_add_u32 v5, v26, v27
    v_add_u32 v6, v5, v28
    v_add_u32 v7, v6, v29
    v_mov_b32 v3, v7
    v_mul_u32_u24 v96, s57, v48
    v_mul_u32_u24 v98, s57, v49
    v_add_u32_dpp v3, v3, v3 row_shr:1 row_mask:0xf bank_mask:0xf bound_ctrl:0
    v_mul_u32_u24 v100, s57, v50
    v_mul_u32_u24 v102, s57, v51
    v_add_u32_dpp v3, v3, v3 row_shr:2 row_mask:0xf bank_mask:0xf bound_ctrl:0
    v_mul_u32_u24 v104, s57, v52
    v_mul_u32_u24 v106, s57, v53
    v_add_u32_dpp v3, v3, v3 row_shr:4 row_mask:0xf bank_mask:0xf bound_ctrl:0
    v_mul_u32_u24 v108, s57, v54
    v_mul_u32_u24 v110, s57, v55
    v_add_u32_dpp v3, v3, v3 row_shr:8 row_mask:0xf bank_mask:0xf bound_ctrl:0
    v_mul_u32_u24 v112, s57, v56
    v_mul_u32_u24 v114, s57, v57
    v_add_u32_dpp v3, v3, v3 row_bcast:15 row_mask:0xa bank_mask:0xf
    v_mul_u32_u24 v116, s57, v58
    v_mul_u32_u24 v118, s57, v59
    v_add_u32_dpp v3, v3, v3 row_bcast:31 row_mask:0xc bank_mask:0xf
    v_sub_u32 v4, v3, v7
    v_add_u32 v7, v4, v6
    v_add_u32 v6, v4, v5
    v_add_u32 v5, v4, v26
    ds_write_b128 v9, v[4:7] offset:7168
    ds_read_b32 v64, v64 offset:7168
    ds_read_b32 v65, v65 offset:7168
    ds_read_b32 v66, v66 offset:7168
    ds_read_b32 v67, v67 offset:7168
    ds_read_b32 v68, v68 offset:7168
    ds_read_b32 v69, v69 offset:7168
    ds_read_b32 v70, v70 offset:7168
    ds_read_b32 v71, v71 offset:7168
    ds_read_b32 v72, v72 offset:7168
    ds_read_b32 v73, v73 offset:7168
    ds_read_b32 v74, v74 offset:7168
    ds_read_b32 v75, v75 offset:7168
    ds_read_b32 v76, v76 offset:7168
    buffer_load_dwordx4 v[160:163], v21, s[68:71], s35 offen
    s_add_u32 s35, s35, 4096
    buffer_load_dwordx4 v[164:167], v21, s[68:71], s35 offen
    s_add_u32 s35, s35, 4096
    buffer_load_dwordx4 v[168:171], v21, s[68:71], s35 offen
    s_add_u32 s35, s35, 4096
    buffer_load_dwordx4 v[172:175], v21, s[68:71], s35 offen
    s_add_u32 s35, s35, 4096
    buffer_load_dwordx4 v[176:179], v21, s[68:71], s35 offen
    s_add_u32 s35, s35, 4096
    v_mul_u32_u24 v120, s57, v60
    v_lshrrev_b32 v96, 4, v96
    v_lshrrev_b32 v98, 4, v98
    v_lshrrev_b32 v100, 4, v100
    v_lshrrev_b32 v102, 4, v102
    v_lshrrev_b32 v104, 4, v104
    v_lshrrev_b32 v106, 4, v106
    v_lshrrev_b32 v108, 4, v108
    v_lshrrev_b32 v110, 4, v110
    v_lshrrev_b32 v112, 4, v112
    v_lshrrev_b32 v114, 4, v114
    v_lshrrev_b32 v116, 4, v116
    v_lshrrev_b32 v118, 4, v118
    v_lshrrev_b32 v120, 4, v120
    v_and_or_b32 v96, v96, s58, v48
    v_and_or_b32 v98, v98, s58, v49
    v_and_or_b32 v100, v100, s58, v50
    v_and_or_b32 v102, v102, s58, v51
    v_and_or_b32 v104, v104, s58, v52
    v_and_or_b32 v106, v106, s58, v53
    v_and_or_b32 v108, v108, s58, v54
    v_and_or_b32 v110, v110, s58, v55
    v_and_or_b32 v112, v112, s58, v56
    v_and_or_b32 v114, v114, s58, v57
    v_and_or_b32 v116, v116, s58, v58
    v_and_or_b32 v118, v118, s58, v59
    v_and_or_b32 v120, v120, s58, v60
    s_movk_i32 s67, 3000
    s_waitcnt vmcnt(9)
    v_readfirstlane_b32 s82, v122
    v_readfirstlane_b32 s83, v123
    s_cmp_eq_u32 s82, 0
    s_cbranch_scc0 L_ptag_ok
L_ptag:
    global_load_dwordx2 v[122:123], v12, s[62:63] sc1
L_ptag_chk:
    s_waitcnt vmcnt(0)
    v_readfirstlane_b32 s82, v122
    v_readfirstlane_b32 s83, v123
    s_cmp_eq_u32 s82, 0
    s_cbranch_scc0 L_ptag_ok
    s_sub_u32 s67, s67, 1
    s_cbranch_scc0 L_ptag
    s_mov_b32 s66, 1
L_ptag_ok:
    s_and_b32 s83, s83, 0xff
    s_lshl_b32 s84, s82, 4
    s_and_b32 s84, s84, 0xfffff000
    s_sub_u32 s3, 3, s31
    s_or_b32 s3, s3, s66
    s_cbranch_scc1 L_norow
    v_lshl_or_b32 v136, v26, 12, v4
    v_mov_b32 v137, s82
    v_lshl_or_b32 v138, v27, 12, v5
    v_mov_b32 v139, s82
    v_lshl_or_b32 v140, v28, 12, v6
    v_mov_b32 v141, s82
    v_lshl_or_b32 v142, v29, 12, v7
    v_mov_b32 v143, s82
    v_lshl_or_b32 v136, s83, 24, v136
    v_lshl_or_b32 v138, s83, 24, v138
    v_lshl_or_b32 v140, s83, 24, v140
    v_lshl_or_b32 v142, s83, 24, v142
    s_mul_i32 s3, s2, 2304
    s_add_u32 s3, s3, 8388608
    v_lshlrev_b32 v3, 5, v2
    buffer_store_dwordx4 v[136:139], v3, s[20:23], s3 offen sc1
    buffer_store_dwordx4 v[140:143], v3, s[20:23], s3 offen offset:16 sc1
L_norow:
    s_lshl_b32 s3, s84, 16
    v_add_u32 v22, s84, v15
    v_add_u32 v20, s84, v0
    s_waitcnt lgkmcnt(0)
    v_or3_b32 v96, v96, v32, s3
    v_add_u32 v97, 0, v22
    v_or3_b32 v98, v98, v33, s3
    v_add_u32 v99, 1, v22
    v_or3_b32 v100, v100, v34, s3
    v_add_u32 v101, 2, v22
    v_or3_b32 v102, v102, v35, s3
    v_add_u32 v103, 3, v22
    v_add_lshl_u32 v64, v64, v80, 3
    v_add_lshl_u32 v65, v65, v81, 3
    v_add_lshl_u32 v66, v66, v82, 3
    v_add_lshl_u32 v67, v67, v83, 3
    ds_write_b64 v64, v[96:97] offset:8192
    ds_write_b64 v65, v[98:99] offset:8192
    ds_write_b64 v66, v[100:101] offset:8192
    ds_write_b64 v67, v[102:103] offset:8192
    v_or3_b32 v104, v104, v36, s3
    v_add_u32 v105, 1024, v22
    v_or3_b32 v106, v106, v37, s3
    v_add_u32 v107, 1025, v22
    v_or3_b32 v108, v108, v38, s3
    v_add_u32 v109, 1026, v22
    v_or3_b32 v110, v110, v39, s3
    v_add_u32 v111, 1027, v22
    v_add_lshl_u32 v68, v68, v84, 3
    v_add_lshl_u32 v69, v69, v85, 3
    v_add_lshl_u32 v70, v70, v86, 3
    v_add_lshl_u32 v71, v71, v87, 3
    ds_write_b64 v68, v[104:105] offset:8192
    ds_write_b64 v69, v[106:107] offset:8192
    ds_write_b64 v70, v[108:109] offset:8192
    ds_write_b64 v71, v[110:111] offset:8192
    v_or3_b32 v112, v112, v40, s3
    v_add_u32 v113, 2048, v22
    v_or3_b32 v114, v114, v41, s3
    v_add_u32 v115, 2049, v22
    v_or3_b32 v116, v116, v42, s3
    v_add_u32 v117, 2050, v22
    v_or3_b32 v118, v118, v43, s3
    v_add_u32 v119, 2051, v22
    v_or3_b32 v120, v120, v44, s3
    v_add_u32 v121, 3072, v20
    v_add_lshl_u32 v72, v72, v88, 3
    v_add_lshl_u32 v73, v73, v89, 3
    v_add_lshl_u32 v74, v74, v90, 3
    v_add_lshl_u32 v75, v75, v91, 3
    v_add_lshl_u32 v76, v76, v92, 3
    ds_write_b64 v72, v[112:113] offset:8192
    ds_write_b64 v73, v[114:115] offset:8192
    ds_write_b64 v74, v[116:117] offset:8192
    ds_write_b64 v75, v[118:119] offset:8192
    s_mov_b64 exec, s[76:77]
    ds_write_b64 v76, v[120:121] offset:8192
    s_mov_b64 exec, -1
    v_lshlrev_b32 v10, 16, v10
    v_mul_f32 v10, s34, v10
    ds_write_b32 v15, v10 offset:6144
    v_lshl_add_u32 v20, v1, 7, v9
    s_and_b32 s3, s2, 31
    s_lshl_b32 s35, s2, 8
    s_add_u32 s3, s3, s35
    s_lshl_b32 s3, s3, 7
    s_waitcnt lgkmcnt(0)
    s_barrier
    ds_read_b128 v[32:35], v21 offset:8192
    ds_read_b128 v[36:39], v21 offset:12288
    ds_read_b128 v[40:43], v21 offset:16384
    ds_read_b128 v[44:47], v21 offset:20480
    ds_read_b128 v[48:51], v21 offset:24576
    ds_read_b128 v[52:55], v21 offset:28672
    ds_read_b128 v[56:59], v20 offset:32768
    s_waitcnt lgkmcnt(6)
    buffer_store_dwordx4 v[32:35], v21, s[20:23], s3 offen sc1
    s_add_u32 s3, s3, 4096
    s_waitcnt lgkmcnt(5)
    buffer_store_dwordx4 v[36:39], v21, s[20:23], s3 offen sc1
    s_add_u32 s3, s3, 4096
    s_waitcnt lgkmcnt(4)
    buffer_store_dwordx4 v[40:43], v21, s[20:23], s3 offen sc1
    s_add_u32 s3, s3, 4096
    s_waitcnt lgkmcnt(3)
    buffer_store_dwordx4 v[44:47], v21, s[20:23], s3 offen sc1
    s_add_u32 s3, s3, 4096
    s_waitcnt lgkmcnt(2)
    buffer_store_dwordx4 v[48:51], v21, s[20:23], s3 offen sc1
    s_add_u32 s3, s3, 4096
    s_waitcnt lgkmcnt(1)
    buffer_store_dwordx4 v[52:55], v21, s[20:23], s3 offen sc1
    s_add_u32 s3, s3, 4096
    s_waitcnt lgkmcnt(0)
    s_mov_b64 exec, 0xff
    buffer_store_dwordx4 v[56:59], v20, s[20:23], s3 offen sc1
    s_mov_b64 exec, -1
    s_lshl_b32 s35, s31, 12
    s_add_u32 m0, s35, 147456
    s_barrier
    ds_write_b32 v15, v11 offset:7168
    v_and_b32 v3, 0x30, v0
    v_lshlrev_b32 v3, 2, v3
    v_xor_b32 v3, v3, v21
    v_add_u32 v3, 110592, v3
    s_mov_b32 s56, 3216550459
    s_mov_b32 s57, s56
    s_mov_b32 s3, 0xffff0000
    s_waitcnt vmcnt(7)
L_wok:
    v_lshlrev_b32 v64, 16, v144
    v_and_b32 v65, s3, v144
    v_lshlrev_b32 v66, 16, v145
    v_and_b32 v67, s3, v145
    v_lshlrev_b32 v68, 16, v146
    v_and_b32 v69, s3, v146
    v_lshlrev_b32 v70, 16, v147
    v_and_b32 v71, s3, v147
    v_pk_mul_f32 v[64:65], v[64:65], s[56:57]
    v_pk_mul_f32 v[66:67], v[66:67], s[56:57]
    v_pk_mul_f32 v[68:69], v[68:69], s[56:57]
    v_pk_mul_f32 v[70:71], v[70:71], s[56:57]
    v_cvt_pk_bf16_f32 v144, v64, v65
    v_cvt_pk_bf16_f32 v145, v66, v67
    v_cvt_pk_bf16_f32 v146, v68, v69
    v_cvt_pk_bf16_f32 v147, v70, v71
    ds_write_b128 v3, v[144:147] offset:0
    ds_write_b128 v132, v[128:131] offset:8192
    v_lshlrev_b32 v64, 16, v148
    v_and_b32 v65, s3, v148
    v_lshlrev_b32 v66, 16, v149
    v_and_b32 v67, s3, v149
    v_lshlrev_b32 v68, 16, v150
    v_and_b32 v69, s3, v150
    v_lshlrev_b32 v70, 16, v151
    v_and_b32 v71, s3, v151
    v_pk_mul_f32 v[64:65], v[64:65], s[56:57]
    v_pk_mul_f32 v[66:67], v[66:67], s[56:57]
    v_pk_mul_f32 v[68:69], v[68:69], s[56:57]
    v_pk_mul_f32 v[70:71], v[70:71], s[56:57]
    v_cvt_pk_bf16_f32 v148, v64, v65
    v_cvt_pk_bf16_f32 v149, v66, v67
    v_cvt_pk_bf16_f32 v150, v68, v69
    v_cvt_pk_bf16_f32 v151, v70, v71
    ds_write_b128 v3, v[148:151] offset:4096
    ds_write_b128 v132, v[128:131] offset:4096
    v_lshlrev_b32 v64, 16, v152
    v_and_b32 v65, s3, v152
    v_lshlrev_b32 v66, 16, v153
    v_and_b32 v67, s3, v153
    v_lshlrev_b32 v68, 16, v154
    v_and_b32 v69, s3, v154
    v_lshlrev_b32 v70, 16, v155
    v_and_b32 v71, s3, v155
    v_pk_mul_f32 v[64:65], v[64:65], s[56:57]
    v_pk_mul_f32 v[66:67], v[66:67], s[56:57]
    v_pk_mul_f32 v[68:69], v[68:69], s[56:57]
    v_pk_mul_f32 v[70:71], v[70:71], s[56:57]
    v_cvt_pk_bf16_f32 v152, v64, v65
    v_cvt_pk_bf16_f32 v153, v66, v67
    v_cvt_pk_bf16_f32 v154, v68, v69
    v_cvt_pk_bf16_f32 v155, v70, v71
    ds_write_b128 v3, v[152:155] offset:8192
    ds_write_b128 v132, v[128:131] offset:0
    v_lshlrev_b32 v64, 16, v156
    v_and_b32 v65, s3, v156
    v_lshlrev_b32 v66, 16, v157
    v_and_b32 v67, s3, v157
    v_lshlrev_b32 v68, 16, v158
    v_and_b32 v69, s3, v158
    v_lshlrev_b32 v70, 16, v159
    v_and_b32 v71, s3, v159
    v_pk_mul_f32 v[64:65], v[64:65], s[56:57]
    v_pk_mul_f32 v[66:67], v[66:67], s[56:57]
    v_pk_mul_f32 v[68:69], v[68:69], s[56:57]
    v_pk_mul_f32 v[70:71], v[70:71], s[56:57]
    v_cvt_pk_bf16_f32 v156, v64, v65
    v_cvt_pk_bf16_f32 v157, v66, v67
    v_cvt_pk_bf16_f32 v158, v68, v69
    v_cvt_pk_bf16_f32 v159, v70, v71
    ds_write_b128 v3, v[156:159] offset:12288
    ds_write_b128 v21, v[128:131] offset:8192
    v_lshlrev_b32 v64, 16, v160
    v_and_b32 v65, s3, v160
    v_lshlrev_b32 v66, 16, v161
    v_and_b32 v67, s3, v161
    v_lshlrev_b32 v68, 16, v162
    v_and_b32 v69, s3, v162
    v_lshlrev_b32 v70, 16, v163
    v_and_b32 v71, s3, v163
    v_pk_mul_f32 v[64:65], v[64:65], s[56:57]
    v_pk_mul_f32 v[66:67], v[66:67], s[56:57]
    v_pk_mul_f32 v[68:69], v[68:69], s[56:57]
    v_pk_mul_f32 v[70:71], v[70:71], s[56:57]
    v_cvt_pk_bf16_f32 v160, v64, v65
    v_cvt_pk_bf16_f32 v161, v66, v67
    v_cvt_pk_bf16_f32 v162, v68, v69
    v_cvt_pk_bf16_f32 v163, v70, v71
    ds_write_b128 v3, v[160:163] offset:16384
    ds_write_b128 v21, v[128:131] offset:12288
    v_lshlrev_b32 v64, 16, v164
    v_and_b32 v65, s3, v164
    v_lshlrev_b32 v66, 16, v165
    v_and_b32 v67, s3, v165
    v_lshlrev_b32 v68, 16, v166
    v_and_b32 v69, s3, v166
    v_lshlrev_b32 v70, 16, v167
    v_and_b32 v71, s3, v167
    v_pk_mul_f32 v[64:65], v[64:65], s[56:57]
    v_pk_mul_f32 v[66:67], v[66:67], s[56:57]
    v_pk_mul_f32 v[68:69], v[68:69], s[56:57]
    v_pk_mul_f32 v[70:71], v[70:71], s[56:57]
    v_cvt_pk_bf16_f32 v164, v64, v65
    v_cvt_pk_bf16_f32 v165, v66, v67
    v_cvt_pk_bf16_f32 v166, v68, v69
    v_cvt_pk_bf16_f32 v167, v70, v71
    ds_write_b128 v3, v[164:167] offset:20480
    ds_write_b128 v21, v[128:131] offset:16384
    v_lshlrev_b32 v64, 16, v168
    v_and_b32 v65, s3, v168
    v_lshlrev_b32 v66, 16, v169
    v_and_b32 v67, s3, v169
    v_lshlrev_b32 v68, 16, v170
    v_and_b32 v69, s3, v170
    v_lshlrev_b32 v70, 16, v171
    v_and_b32 v71, s3, v171
    v_pk_mul_f32 v[64:65], v[64:65], s[56:57]
    v_pk_mul_f32 v[66:67], v[66:67], s[56:57]
    v_pk_mul_f32 v[68:69], v[68:69], s[56:57]
    v_pk_mul_f32 v[70:71], v[70:71], s[56:57]
    v_cvt_pk_bf16_f32 v168, v64, v65
    v_cvt_pk_bf16_f32 v169, v66, v67
    v_cvt_pk_bf16_f32 v170, v68, v69
    v_cvt_pk_bf16_f32 v171, v70, v71
    ds_write_b128 v3, v[168:171] offset:24576
    ds_write_b128 v21, v[128:131] offset:20480
    v_lshlrev_b32 v64, 16, v172
    v_and_b32 v65, s3, v172
    v_lshlrev_b32 v66, 16, v173
    v_and_b32 v67, s3, v173
    v_lshlrev_b32 v68, 16, v174
    v_and_b32 v69, s3, v174
    v_lshlrev_b32 v70, 16, v175
    v_and_b32 v71, s3, v175
    v_pk_mul_f32 v[64:65], v[64:65], s[56:57]
    v_pk_mul_f32 v[66:67], v[66:67], s[56:57]
    v_pk_mul_f32 v[68:69], v[68:69], s[56:57]
    v_pk_mul_f32 v[70:71], v[70:71], s[56:57]
    v_cvt_pk_bf16_f32 v172, v64, v65
    v_cvt_pk_bf16_f32 v173, v66, v67
    v_cvt_pk_bf16_f32 v174, v68, v69
    v_cvt_pk_bf16_f32 v175, v70, v71
    ds_write_b128 v3, v[172:175] offset:28672
    v_lshlrev_b32 v64, 16, v176
    v_and_b32 v65, s3, v176
    v_lshlrev_b32 v66, 16, v177
    v_and_b32 v67, s3, v177
    v_lshlrev_b32 v68, 16, v178
    v_and_b32 v69, s3, v178
    v_lshlrev_b32 v70, 16, v179
    v_and_b32 v71, s3, v179
    v_pk_mul_f32 v[64:65], v[64:65], s[56:57]
    v_pk_mul_f32 v[66:67], v[66:67], s[56:57]
    v_pk_mul_f32 v[68:69], v[68:69], s[56:57]
    v_pk_mul_f32 v[70:71], v[70:71], s[56:57]
    v_cvt_pk_bf16_f32 v176, v64, v65
    v_cvt_pk_bf16_f32 v177, v66, v67
    v_cvt_pk_bf16_f32 v178, v68, v69
    v_cvt_pk_bf16_f32 v179, v70, v71
    ds_write_b128 v3, v[176:179] offset:32768
    v_lshrrev_b32 v64, 5, v2
    v_bfe_u32 v65, v2, 2, 2
    v_bfe_u32 v66, v2, 4, 1
    v_and_b32 v67, 3, v2
    v_lshl_add_u32 v200, v64, 3, v65
    v_lshlrev_b32 v200, 8, v200
    v_lshl_add_u32 v200, v66, 5, v200
    v_lshl_add_u32 v200, v67, 3, v200
    v_lshl_add_u32 v200, v65, 6, v200
    v_add_u32 v200, 110592, v200
    v_xor_b32 v201, 64, v200
    v_xor_b32 v202, 128, v200
    v_xor_b32 v203, 192, v200
    v_lshl_add_u32 v204, v64, 2, v65
    v_lshlrev_b32 v204, 7, v204
    v_lshl_add_u32 v204, v66, 4, v204
    v_and_b32 v64, 1, v2
    v_lshl_add_u32 v204, v64, 6, v204
    v_bfe_u32 v64, v2, 1, 1
    v_lshl_add_u32 v204, v64, 3, v204
    v_add_u32 v204, 147456, v204
    s_waitcnt lgkmcnt(0)
    s_barrier
    buffer_load_dwordx2 v[16:17], v30, s[20:23], s33 offen sc1
    ds_read_b64_tr_b16 a[0:1], v200 offset:0
    ds_read_b64_tr_b16 a[2:3], v200 offset:1024
    ds_read_b64_tr_b16 a[16:17], v201 offset:0
    ds_read_b64_tr_b16 a[18:19], v201 offset:1024
    ds_read_b64_tr_b16 a[32:33], v202 offset:0
    ds_read_b64_tr_b16 a[34:35], v202 offset:1024
    ds_read_b64_tr_b16 a[48:49], v203 offset:0
    ds_read_b64_tr_b16 a[50:51], v203 offset:1024
    ds_read_b64_tr_b16 a[4:5], v200 offset:4096
    ds_read_b64_tr_b16 a[6:7], v200 offset:5120
    ds_read_b64_tr_b16 a[20:21], v201 offset:4096
    ds_read_b64_tr_b16 a[22:23], v201 offset:5120
    ds_read_b64_tr_b16 a[36:37], v202 offset:4096
    ds_read_b64_tr_b16 a[38:39], v202 offset:5120
    ds_read_b64_tr_b16 a[52:53], v203 offset:4096
    ds_read_b64_tr_b16 a[54:55], v203 offset:5120
    ds_read_b64_tr_b16 a[8:9], v200 offset:8192
    ds_read_b64_tr_b16 a[10:11], v200 offset:9216
    ds_read_b64_tr_b16 a[24:25], v201 offset:8192
    ds_read_b64_tr_b16 a[26:27], v201 offset:9216
    ds_read_b64_tr_b16 a[40:41], v202 offset:8192
    ds_read_b64_tr_b16 a[42:43], v202 offset:9216
    ds_read_b64_tr_b16 a[56:57], v203 offset:8192
    ds_read_b64_tr_b16 a[58:59], v203 offset:9216
    ds_read_b64_tr_b16 a[12:13], v200 offset:12288
    ds_read_b64_tr_b16 a[14:15], v200 offset:13312
    ds_read_b64_tr_b16 a[28:29], v201 offset:12288
    ds_read_b64_tr_b16 a[30:31], v201 offset:13312
    ds_read_b64_tr_b16 a[44:45], v202 offset:12288
    ds_read_b64_tr_b16 a[46:47], v202 offset:13312
    ds_read_b64_tr_b16 a[60:61], v203 offset:12288
    ds_read_b64_tr_b16 a[62:63], v203 offset:13312
    ds_read_b64_tr_b16 a[80:81], v200 offset:16384
    ds_read_b64_tr_b16 a[82:83], v200 offset:17408
    ds_read_b64_tr_b16 a[96:97], v201 offset:16384
    ds_read_b64_tr_b16 a[98:99], v201 offset:17408
    ds_read_b64_tr_b16 a[112:113], v202 offset:16384
    ds_read_b64_tr_b16 a[114:115], v202 offset:17408
    ds_read_b64_tr_b16 a[128:129], v203 offset:16384
    ds_read_b64_tr_b16 a[130:131], v203 offset:17408
    ds_read_b64_tr_b16 a[84:85], v200 offset:20480
    ds_read_b64_tr_b16 a[86:87], v200 offset:21504
    ds_read_b64_tr_b16 a[100:101], v201 offset:20480
    ds_read_b64_tr_b16 a[102:103], v201 offset:21504
    ds_read_b64_tr_b16 a[116:117], v202 offset:20480
    ds_read_b64_tr_b16 a[118:119], v202 offset:21504
    ds_read_b64_tr_b16 a[132:133], v203 offset:20480
    ds_read_b64_tr_b16 a[134:135], v203 offset:21504
    ds_read_b64_tr_b16 a[88:89], v200 offset:24576
    ds_read_b64_tr_b16 a[90:91], v200 offset:25600
    ds_read_b64_tr_b16 a[104:105], v201 offset:24576
    ds_read_b64_tr_b16 a[106:107], v201 offset:25600
    ds_read_b64_tr_b16 a[120:121], v202 offset:24576
    ds_read_b64_tr_b16 a[122:123], v202 offset:25600
    ds_read_b64_tr_b16 a[136:137], v203 offset:24576
    ds_read_b64_tr_b16 a[138:139], v203 offset:25600
    ds_read_b64_tr_b16 a[92:93], v200 offset:28672
    ds_read_b64_tr_b16 a[94:95], v200 offset:29696
    ds_read_b64_tr_b16 a[108:109], v201 offset:28672
    ds_read_b64_tr_b16 a[110:111], v201 offset:29696
    ds_read_b64_tr_b16 a[124:125], v202 offset:28672
    ds_read_b64_tr_b16 a[126:127], v202 offset:29696
    ds_read_b64_tr_b16 a[140:141], v203 offset:28672
    ds_read_b64_tr_b16 a[142:143], v203 offset:29696
    ds_read_b64_tr_b16 a[64:65], v200 offset:32768
    ds_read_b64_tr_b16 a[66:67], v200 offset:33792
    ds_read_b64_tr_b16 a[68:69], v201 offset:32768
    ds_read_b64_tr_b16 a[70:71], v201 offset:33792
    ds_read_b64_tr_b16 a[72:73], v202 offset:32768
    ds_read_b64_tr_b16 a[74:75], v202 offset:33792
    ds_read_b64_tr_b16 a[76:77], v203 offset:32768
    ds_read_b64_tr_b16 a[78:79], v203 offset:33792
    v_lshrrev_b32 v29, 3, v2
    v_xor_b32 v29, v29, v2
    v_lshlrev_b32 v29, 4, v29
    s_mul_i32 s85, s31, 7168
    s_lshl_b32 s3, s29, 7
    s_add_u32 s3, s3, s85
    v_add_u32 v29, s3, v29
    s_waitcnt lgkmcnt(0)
    s_barrier
    buffer_load_dwordx4 v9, s[72:75], s35 offen offset:0 lds
    buffer_load_dwordx4 v9, s[72:75], s35 offen offset:1024 lds
    buffer_load_dwordx4 v9, s[72:75], s35 offen offset:2048 lds
    buffer_load_dwordx4 v9, s[72:75], s35 offen offset:3072 lds
    s_waitcnt vmcnt(4)
L_consume:
    s_cmp_lg_u32 s66, 0
    s_cbranch_scc1 L_skipB
    s_movk_i32 s67, 3000
    v_cmp_ne_u32 s[56:57], s82, v17
    v_cmp_ne_u32_sdwa vcc, v16, s83 src0_sel:BYTE_3 src1_sel:DWORD
    s_or_b64 vcc, vcc, s[56:57]
    s_cbranch_scc0 L_pt_ok
L_pt:
    s_mov_b64 exec, vcc
    buffer_load_dwordx2 v[16:17], v30, s[20:23], s33 offen sc1
    s_mov_b64 exec, -1
L_pt_chk:
    s_waitcnt vmcnt(0)
    v_cmp_ne_u32 s[56:57], s82, v17
    v_cmp_ne_u32_sdwa vcc, v16, s83 src0_sel:BYTE_3 src1_sel:DWORD
    s_or_b64 vcc, vcc, s[56:57]
    s_cbranch_scc0 L_pt_ok
    s_sub_u32 s67, s67, 1
    s_cbranch_scc0 L_pt
    s_mov_b32 s66, 1
L_pt_ok:
    v_bfe_u32 v17, v16, 12, 12
    v_and_b32 v16, 0xfff, v16
    v_mov_b32 v18, v17
    v_add_u32 v16, v16, v31
    v_add_lshl_u32 v22, v16, v17, 3
    v_sub_u32_e64 v22, v22, 4 clamp
    buffer_load_dword v23, v22, s[20:23], 0 offen sc1
    v_cmp_lt_u32 s[56:57], 16, v17
    v_cmp_lt_u32 s[58:59], 8, v17
    v_add_u32_dpp v18, v18, v18 row_shr:1 row_mask:0xf bank_mask:0xf bound_ctrl:0
    v_cmp_lt_u32 s[60:61], 0, v17
    v_cmp_lt_u32 vcc, 24, v17
    v_add_u32_dpp v18, v18, v18 row_shr:2 row_mask:0xf bank_mask:0xf bound_ctrl:0
    v_add_u32 v20, s32, v19
    s_nop 0
    v_add_u32_dpp v18, v18, v18 row_shr:4 row_mask:0xf bank_mask:0xf bound_ctrl:0
    s_nop 1
    v_add_u32_dpp v18, v18, v18 row_shr:8 row_mask:0xf bank_mask:0xf bound_ctrl:0
    s_nop 1
    v_add_u32_dpp v18, v18, v18 row_bcast:15 row_mask:0xa bank_mask:0xf
    s_nop 1
    v_add_u32_dpp v18, v18, v18 row_bcast:31 row_mask:0xc bank_mask:0xf
    v_sub_u32 v3, v18, v17
    v_readlane_b32 s3, v18, 63
    v_sub_u32 v16, v16, v3
    v_lshl_add_u32 v18, v3, 2, s32
    v_lshlrev_b32 v16, 3, v16
    s_cmp_gt_u32 s3, 960
    s_cselect_b32 s66, 1, s66
    s_cmp_lg_u32 s66, 0
    s_cbranch_scc1 L_skipB
    v_lshl_add_u32 v3, s3, 2, v20
    s_mov_b64 exec, s[56:57]
    ds_write_b32 v18, v16 offset:92
    ds_write_b32 v18, v16 offset:88
    ds_write_b32 v18, v16 offset:84
    ds_write_b32 v18, v16 offset:80
    ds_write_b32 v18, v16 offset:76
    ds_write_b32 v18, v16 offset:72
    ds_write_b32 v18, v16 offset:68
    ds_write_b32 v18, v16 offset:64
    s_mov_b64 exec, s[58:59]
    ds_write_b32 v18, v16 offset:60
    ds_write_b32 v18, v16 offset:56
    ds_write_b32 v18, v16 offset:52
    ds_write_b32 v18, v16 offset:48
    ds_write_b32 v18, v16 offset:44
    ds_write_b32 v18, v16 offset:40
    ds_write_b32 v18, v16 offset:36
    ds_write_b32 v18, v16 offset:32
    s_mov_b64 exec, s[60:61]
    ds_write_b32 v18, v16 offset:28
    ds_write_b32 v18, v16 offset:24
    ds_write_b32 v18, v16 offset:20
    ds_write_b32 v18, v16 offset:16
    ds_write_b32 v18, v16 offset:12
    ds_write_b32 v18, v16 offset:8
    ds_write_b32 v18, v16 offset:4
    ds_write_b32 v18, v16 offset:0
    s_mov_b64 exec, -1
    ds_write_b32 v3, v128
    s_cbranch_vccz L_nomap
L_map:
    v_cmpx_lt_u32 vcc, 24, v17
    ds_write_b32 v18, v16 offset:96
    v_cmpx_lt_u32 vcc, 25, v17
    ds_write_b32 v18, v16 offset:100
    v_cmpx_lt_u32 vcc, 26, v17
    ds_write_b32 v18, v16 offset:104
    v_cmpx_lt_u32 vcc, 27, v17
    ds_write_b32 v18, v16 offset:108
    v_add_u32 v18, 16, v18
    v_subrev_u32 v17, 4, v17
    s_cbranch_execnz L_map
    s_mov_b64 exec, -1
L_nomap:
    ds_read_b32 v144, v20 offset:0
    ds_read_b32 v145, v20 offset:256
    ds_read_b32 v146, v20 offset:512
    ds_read_b32 v147, v20 offset:768
    ds_read_b32 v148, v20 offset:1024
    ds_read_b32 v149, v20 offset:1280
    ds_read_b32 v150, v20 offset:1536
    ds_read_b32 v151, v20 offset:1792
    ds_read_b32 v152, v20 offset:2048
    ds_read_b32 v153, v20 offset:2304
    ds_read_b32 v154, v20 offset:2560
    ds_read_b32 v155, v20 offset:2816
    ds_read_b32 v156, v20 offset:3072
    ds_read_b32 v157, v20 offset:3328
    ds_read_b32 v158, v20 offset:3584
    s_movk_i32 s34, 4096
    s_waitcnt lgkmcnt(0)
    v_add_u32 v144, v144, v14
    v_add_u32 v145, v145, v14
    v_add_u32 v146, v146, v14
    v_add_u32 v147, v147, v14
    v_add_u32 v148, v148, v14
    v_add_u32 v149, v149, v14
    v_add_u32 v150, v150, v14
    v_add_u32 v151, v151, v14
    v_add_u32 v152, v152, v14
    v_add_u32 v153, v153, v14
    v_add_u32 v154, v154, v14
    v_add_u32 v155, v155, v14
    v_add_u32 v156, v156, v14
    v_add_u32 v157, v157, v14
    v_add_u32 v158, v158, v14
    s_waitcnt vmcnt(0)
    s_movk_i32 s67, 3000
    v_xor_b32 v3, s84, v23
    v_cmp_lt_u32 vcc, 0xfff, v3
    s_and_b64 vcc, vcc, s[60:61]
    s_cbranch_scc0 L_pp_ok
L_pp:
    s_mov_b64 exec, vcc
    buffer_load_dword v23, v22, s[20:23], 0 offen sc1
    s_mov_b64 exec, -1
L_pp_chk:
    s_waitcnt vmcnt(0)
    v_xor_b32 v3, s84, v23
    v_cmp_lt_u32 vcc, 0xfff, v3
    s_and_b64 vcc, vcc, s[60:61]
    s_cbranch_scc0 L_pp_ok
    s_sub_u32 s67, s67, 1
    s_cbranch_scc0 L_pp
    s_mov_b32 s66, 1
L_pp_ok:
    s_cmp_lg_u32 s66, 0
    s_cbranch_scc1 L_skipB
    buffer_load_dwordx2 v[32:33], v144, s[20:23], 0 offen offset:0 sc1
    buffer_load_dwordx2 v[34:35], v145, s[20:23], 0 offen offset:512 sc1
    buffer_load_dwordx2 v[36:37], v146, s[20:23], 0 offen offset:1024 sc1
    buffer_load_dwordx2 v[38:39], v147, s[20:23], 0 offen offset:1536 sc1
    buffer_load_dwordx2 v[40:41], v148, s[20:23], 0 offen offset:2048 sc1
    buffer_load_dwordx2 v[42:43], v149, s[20:23], 0 offen offset:2560 sc1
    buffer_load_dwordx2 v[44:45], v150, s[20:23], 0 offen offset:3072 sc1
    buffer_load_dwordx2 v[46:47], v151, s[20:23], 0 offen offset:3584 sc1
    buffer_load_dwordx2 v[48:49], v152, s[20:23], s34 offen offset:0 sc1
    buffer_load_dwordx2 v[50:51], v153, s[20:23], s34 offen offset:512 sc1
    buffer_load_dwordx2 v[52:53], v154, s[20:23], s34 offen offset:1024 sc1
    buffer_load_dwordx2 v[54:55], v155, s[20:23], s34 offen offset:1536 sc1
    buffer_load_dwordx2 v[56:57], v156, s[20:23], s34 offen offset:2048 sc1
    buffer_load_dwordx2 v[58:59], v157, s[20:23], s34 offen offset:2560 sc1
    buffer_load_dwordx2 v[60:61], v158, s[20:23], s34 offen offset:3072 sc1
    v_bfe_i32 v160, v144, 30, 1
    v_bfe_i32 v161, v145, 30, 1
    v_bfe_i32 v162, v146, 30, 1
    v_bfe_i32 v163, v147, 30, 1
    v_bfe_i32 v164, v148, 30, 1
    v_bfe_i32 v165, v149, 30, 1
    v_bfe_i32 v166, v150, 30, 1
    v_bfe_i32 v167, v151, 30, 1
    v_bfe_i32 v168, v152, 30, 1
    v_bfe_i32 v169, v153, 30, 1
    v_bfe_i32 v170, v154, 30, 1
    v_bfe_i32 v171, v155, 30, 1
    v_bfe_i32 v172, v156, 30, 1
    v_bfe_i32 v173, v157, 30, 1
    v_bfe_i32 v174, v158, 30, 1
    v_bfi_b32 v160, v160, v135, s84
    v_bfi_b32 v161, v161, v135, s84
    v_bfi_b32 v162, v162, v135, s84
    v_bfi_b32 v163, v163, v135, s84
    v_bfi_b32 v164, v164, v135, s84
    v_bfi_b32 v165, v165, v135, s84
    v_bfi_b32 v166, v166, v135, s84
    v_bfi_b32 v167, v167, v135, s84
    v_bfi_b32 v168, v168, v135, s84
    v_bfi_b32 v169, v169, v135, s84
    v_bfi_b32 v170, v170, v135, s84
    v_bfi_b32 v171, v171, v135, s84
    v_bfi_b32 v172, v172, v135, s84
    v_bfi_b32 v173, v173, v135, s84
    v_bfi_b32 v174, v174, v135, s84
    s_mov_b32 s3, 100000
    v_add_u32 v176, 0, v144
    v_add_u32 v177, 512, v145
    v_add_u32 v178, 1024, v146
    v_add_u32 v179, 1536, v147
    v_add_u32 v180, 2048, v148
    v_add_u32 v181, 2560, v149
    v_add_u32 v182, 3072, v150
    v_add_u32 v183, 3584, v151
    v_add_u32 v184, 4096, v152
    v_add_u32 v185, 4608, v153
    v_add_u32 v186, 5120, v154
    v_add_u32 v187, 5632, v155
    v_add_u32 v188, 6144, v156
    v_add_u32 v189, 6656, v157
    v_add_u32 v190, 7168, v158
    v_lshrrev_b32 v176, 15, v176
    v_lshrrev_b32 v177, 15, v177
    v_lshrrev_b32 v178, 15, v178
    v_lshrrev_b32 v179, 15, v179
    v_lshrrev_b32 v180, 15, v180
    v_lshrrev_b32 v181, 15, v181
    v_lshrrev_b32 v182, 15, v182
    v_lshrrev_b32 v183, 15, v183
    v_lshrrev_b32 v184, 15, v184
    v_lshrrev_b32 v185, 15, v185
    v_lshrrev_b32 v186, 15, v186
    v_lshrrev_b32 v187, 15, v187
    v_lshrrev_b32 v188, 15, v188
    v_lshrrev_b32 v189, 15, v189
    v_lshrrev_b32 v190, 15, v190
    v_mul_u32_u24 v176, s3, v176
    v_mul_u32_u24 v177, s3, v177
    v_mul_u32_u24 v178, s3, v178
    v_mul_u32_u24 v179, s3, v179
    v_mul_u32_u24 v180, s3, v180
    v_mul_u32_u24 v181, s3, v181
    v_mul_u32_u24 v182, s3, v182
    v_mul_u32_u24 v183, s3, v183
    v_mul_u32_u24 v184, s3, v184
    v_mul_u32_u24 v185, s3, v185
    v_mul_u32_u24 v186, s3, v186
    v_mul_u32_u24 v187, s3, v187
    v_mul_u32_u24 v188, s3, v188
    v_mul_u32_u24 v189, s3, v189
    v_mul_u32_u24 v190, s3, v190
    s_movk_i32 s67, 3000
    s_waitcnt vmcnt(11)
L_chk0:
    v_xor_b32 v33, v160, v33
    v_xor_b32 v35, v161, v35
    v_xor_b32 v37, v162, v37
    v_xor_b32 v39, v163, v39
    v_xor_b32_sdwa v64, v160, v32 dst_sel:DWORD dst_unused:UNUSED_PAD src0_sel:WORD_0 src1_sel:WORD_1
    v_xor_b32_sdwa v65, v161, v34 dst_sel:DWORD dst_unused:UNUSED_PAD src0_sel:WORD_0 src1_sel:WORD_1
    v_xor_b32_sdwa v66, v162, v36 dst_sel:DWORD dst_unused:UNUSED_PAD src0_sel:WORD_0 src1_sel:WORD_1
    v_xor_b32_sdwa v67, v163, v38 dst_sel:DWORD dst_unused:UNUSED_PAD src0_sel:WORD_0 src1_sel:WORD_1
    v_or3_b32 v3, v64, v33, 0
    v_or3_b32 v3, v65, v35, v3
    v_or3_b32 v3, v66, v37, v3
    v_or3_b32 v3, v67, v39, v3
    v_cmp_lt_u32 vcc, 0xfff, v3
    s_cbranch_vccnz L_retry0
    ds_add_rtn_u32 v80, v64, v13 offset:0
    ds_add_rtn_u32 v81, v65, v13 offset:0
    ds_add_rtn_u32 v82, v66, v13 offset:0
    ds_add_rtn_u32 v83, v67, v13 offset:0
    s_movk_i32 s67, 3000
    s_waitcnt vmcnt(7)
L_chk1:
    v_xor_b32 v41, v164, v41
    v_xor_b32 v43, v165, v43
    v_xor_b32 v45, v166, v45
    v_xor_b32 v47, v167, v47
    v_xor_b32_sdwa v68, v164, v40 dst_sel:DWORD dst_unused:UNUSED_PAD src0_sel:WORD_0 src1_sel:WORD_1
    v_xor_b32_sdwa v69, v165, v42 dst_sel:DWORD dst_unused:UNUSED_PAD src0_sel:WORD_0 src1_sel:WORD_1
    v_xor_b32_sdwa v70, v166, v44 dst_sel:DWORD dst_unused:UNUSED_PAD src0_sel:WORD_0 src1_sel:WORD_1
    v_xor_b32_sdwa v71, v167, v46 dst_sel:DWORD dst_unused:UNUSED_PAD src0_sel:WORD_0 src1_sel:WORD_1
    v_or3_b32 v3, v68, v41, 0
    v_or3_b32 v3, v69, v43, v3
    v_or3_b32 v3, v70, v45, v3
    v_or3_b32 v3, v71, v47, v3
    v_cmp_lt_u32 vcc, 0xfff, v3
    s_cbranch_vccnz L_retry1
    ds_add_rtn_u32 v84, v68, v13 offset:0
    ds_add_rtn_u32 v85, v69, v13 offset:0
    ds_add_rtn_u32 v86, v70, v13 offset:0
    ds_add_rtn_u32 v87, v71, v13 offset:0
    s_movk_i32 s67, 3000
    s_waitcnt vmcnt(4)
L_chk2:
    v_xor_b32 v49, v168, v49
    v_xor_b32 v51, v169, v51
    v_xor_b32 v53, v170, v53
    v_xor_b32_sdwa v72, v168, v48 dst_sel:DWORD dst_unused:UNUSED_PAD src0_sel:WORD_0 src1_sel:WORD_1
    v_xor_b32_sdwa v73, v169, v50 dst_sel:DWORD dst_unused:UNUSED_PAD src0_sel:WORD_0 src1_sel:WORD_1
    v_xor_b32_sdwa v74, v170, v52 dst_sel:DWORD dst_unused:UNUSED_PAD src0_sel:WORD_0 src1_sel:WORD_1
    v_or3_b32 v3, v72, v49, 0
    v_or3_b32 v3, v73, v51, v3
    v_or3_b32 v3, v74, v53, v3
    v_cmp_lt_u32 vcc, 0xfff, v3
    s_cbranch_vccnz L_retry2
    ds_add_rtn_u32 v88, v72, v13 offset:0
    ds_add_rtn_u32 v89, v73, v13 offset:0
    ds_add_rtn_u32 v90, v74, v13 offset:0
    s_movk_i32 s67, 3000
    s_waitcnt vmcnt(0)
L_chk3:
    v_xor_b32 v55, v171, v55
    v_xor_b32 v57, v172, v57
    v_xor_b32 v59, v173, v59
    v_xor_b32 v61, v174, v61
    v_xor_b32_sdwa v75, v171, v54 dst_sel:DWORD dst_unused:UNUSED_PAD src0_sel:WORD_0 src1_sel:WORD_1
    v_xor_b32_sdwa v76, v172, v56 dst_sel:DWORD dst_unused:UNUSED_PAD src0_sel:WORD_0 src1_sel:WORD_1
    v_xor_b32_sdwa v77, v173, v58 dst_sel:DWORD dst_unused:UNUSED_PAD src0_sel:WORD_0 src1_sel:WORD_1
    v_xor_b32_sdwa v78, v174, v60 dst_sel:DWORD dst_unused:UNUSED_PAD src0_sel:WORD_0 src1_sel:WORD_1
    v_or3_b32 v3, v75, v55, 0
    v_or3_b32 v3, v76, v57, v3
    v_or3_b32 v3, v77, v59, v3
    v_or3_b32 v3, v78, v61, v3
    v_cmp_lt_u32 vcc, 0xfff, v3
    v_cmp_ne_u32 s[58:59], v135, v75
    v_cmp_ne_u32 s[60:61], v135, v76
    v_cmp_ne_u32 s[62:63], v135, v77
    v_cmp_ne_u32 s[64:65], v135, v78
    s_cbranch_vccnz L_retry3
    s_mov_b64 exec, s[58:59]
    ds_add_rtn_u32 v91, v75, v13 offset:0
    s_mov_b64 exec, s[60:61]
    ds_add_rtn_u32 v92, v76, v13 offset:0
    s_mov_b64 exec, s[62:63]
    ds_add_rtn_u32 v93, v77, v13 offset:0
    s_mov_b64 exec, s[64:65]
    ds_add_rtn_u32 v94, v78, v13 offset:0
    s_mov_b64 exec, -1
    s_add_u32 m0, s85, 115712
    s_movk_i32 s35, 7264
    buffer_load_dwordx4 v29, s[12:15], s36 offen offset:0 lds
    buffer_load_dwordx4 v29, s[12:15], s36 offen offset:1024 lds
    buffer_load_dwordx4 v29, s[12:15], s36 offen offset:2048 lds
    buffer_load_dwordx4 v29, s[12:15], s36 offen offset:3072 lds
    s_add_u32 m0, m0, 4096
    s_nop 0
    buffer_load_dwordx4 v29, s[12:15], s35 offen offset:0 lds
    buffer_load_dwordx4 v29, s[12:15], s35 offen offset:1024 lds
    buffer_load_dwordx4 v29, s[12:15], s35 offen offset:2048 lds
L_skipB:
    s_mov_b64 exec, s[78:79]
    s_waitcnt lgkmcnt(0)
    s_barrier
    ds_read_b128 v[4:7], v134 offset:0
    s_waitcnt lgkmcnt(0)
    v_add_u32 v5, v4, v5
    v_add_u32 v6, v5, v6
    v_add_u32 v16, v6, v7
    v_min_u32 v17, 63, v16
    v_sub_u32 v17, 63, v17
    v_lshlrev_b32 v17, 2, v17
    ds_add_rtn_u32 v18, v17, v13 offset:5120
    v_sub_u32 v26, v16, v4
    v_sub_u32 v27, v16, v5
    v_sub_u32 v28, v16, v6
    v_lshrrev_b32 v23, 1, v16
    v_lshl_or_b32 v23, v23, 16, v24
    v_or_b32 v23, 0xc00000, v23
    s_mov_b64 exec, -1
    v_lshl_add_u32 v33, v33, 5, v176
    v_lshl_add_u32 v35, v35, 5, v177
    v_lshl_add_u32 v37, v37, 5, v178
    s_waitcnt lgkmcnt(0)
    s_barrier
    ds_read_b32 v20, v19 offset:5120
    ds_read_b32 v3, v19 offset:5120
    s_waitcnt lgkmcnt(0)
    v_lshl_add_u32 v39, v39, 5, v179
    v_lshl_add_u32 v41, v41, 5, v180
    v_add_u32_dpp v3, v3, v3 row_shr:1 row_mask:0xf bank_mask:0xf bound_ctrl:0
    v_lshl_add_u32 v43, v43, 5, v181
    v_lshl_add_u32 v45, v45, 5, v182
    v_add_u32_dpp v3, v3, v3 row_shr:2 row_mask:0xf bank_mask:0xf bound_ctrl:0
    v_lshl_add_u32 v47, v47, 5, v183
    v_lshl_add_u32 v49, v49, 5, v184
    v_add_u32_dpp v3, v3, v3 row_shr:4 row_mask:0xf bank_mask:0xf bound_ctrl:0
    v_lshl_add_u32 v51, v51, 5, v185
    v_lshl_add_u32 v53, v53, 5, v186
    v_add_u32_dpp v3, v3, v3 row_shr:8 row_mask:0xf bank_mask:0xf bound_ctrl:0
    v_lshl_add_u32 v55, v55, 5, v187
    v_lshl_add_u32 v57, v57, 5, v188
    v_add_u32_dpp v3, v3, v3 row_bcast:15 row_mask:0xa bank_mask:0xf
    v_lshl_add_u32 v59, v59, 5, v189
    v_lshl_add_u32 v61, v61, 5, v190
    v_add_u32_dpp v3, v3, v3 row_bcast:31 row_mask:0xc bank_mask:0xf
    v_sub_u32 v20, v3, v20
    ds_bpermute_b32 v20, v17, v20
    v_mov_b32 v3, 2147221504
    ds_write_b32 v135, v3 offset:0
    s_mov_b64 exec, s[80:81]
    s_waitcnt lgkmcnt(1)
    v_add_lshl_u32 v20, v20, v18, 2
    ds_read_b32 v22, v20 offset:7168
    s_waitcnt lgkmcnt(0)
    v_and_b32 v3, 0x10000000, v22
    v_lshlrev_b32 v29, 16, v22
    v_cmp_ne_u32 vcc, 0, v3
    v_bfe_u32 v3, v22, 6, 1
    v_add_u32 v16, v16, v3
    v_cndmask_b32 v7, v6, v12, vcc
    v_cndmask_b32 v6, v5, v28, vcc
    v_cndmask_b32 v5, v4, v27, vcc
    v_cndmask_b32 v4, v12, v26, vcc
    v_mad_u32_u24 v4, v4, v29, v22
    v_mad_u32_u24 v5, v5, v29, v22
    v_mad_u32_u24 v6, v6, v29, v22
    v_mad_u32_u24 v7, v7, v29, v22
    ds_write_b128 v134, v[4:7] offset:0
    v_lshrrev_b32 v16, v3, v16
    v_lshrrev_b32 v22, 16, v22
    v_lshl_or_b32 v24, v3, 22, v24
    v_cmp_lt_u32 s[56:57], 30, v16
    v_lshl_or_b32 v24, v16, 16, v24
    v_cmp_ne_u32 vcc, 0, v3
    ds_write_b32 v22, v24 offset:8064
    s_mov_b64 exec, vcc
    ds_write_b32 v22, v23 offset:8128
    s_or_b32 s56, s56, s66
    s_mov_b64 exec, s[56:57]
    ds_write_b32 v12, v13 offset:5376
    s_mov_b64 exec, -1
    s_waitcnt lgkmcnt(0)
    s_barrier
    ds_read_b32 v16, v12 offset:5376
    ds_read_b32 v96, v64 offset:0
    ds_read_b32 v97, v65 offset:0
    ds_read_b32 v98, v66 offset:0
    ds_read_b32 v99, v67 offset:0
    ds_read_b32 v100, v68 offset:0
    ds_read_b32 v101, v69 offset:0
    ds_read_b32 v102, v70 offset:0
    ds_read_b32 v103, v71 offset:0
    ds_read_b32 v104, v72 offset:0
    ds_read_b32 v105, v73 offset:0
    ds_read_b32 v106, v74 offset:0
    ds_read_b32 v107, v75 offset:0
    ds_read_b32 v108, v76 offset:0
    ds_read_b32 v109, v77 offset:0
    s_waitcnt lgkmcnt(12)
    ds_read_b32 v110, v78 offset:0
    ds_read_b32 v17, v25
    v_readfirstlane_b32 s3, v16
    s_cmp_lg_u32 s3, 0
    s_cbranch_scc1 L_slow0
    s_waitcnt lgkmcnt(12)
    v_mul_u32_u24_sdwa v80, v80, v96 dst_sel:DWORD dst_unused:UNUSED_PAD src0_sel:DWORD src1_sel:WORD_0
    v_mul_u32_u24_sdwa v81, v81, v97 dst_sel:DWORD dst_unused:UNUSED_PAD src0_sel:DWORD src1_sel:WORD_0
    v_mul_u32_u24_sdwa v82, v82, v98 dst_sel:DWORD dst_unused:UNUSED_PAD src0_sel:DWORD src1_sel:WORD_0
    v_mul_u32_u24_sdwa v83, v83, v99 dst_sel:DWORD dst_unused:UNUSED_PAD src0_sel:DWORD src1_sel:WORD_0
    v_add_u32_sdwa v96, v80, v96 dst_sel:DWORD dst_unused:UNUSED_PAD src0_sel:DWORD src1_sel:WORD_1
    v_add_u32_sdwa v97, v81, v97 dst_sel:DWORD dst_unused:UNUSED_PAD src0_sel:DWORD src1_sel:WORD_1
    v_add_u32_sdwa v98, v82, v98 dst_sel:DWORD dst_unused:UNUSED_PAD src0_sel:DWORD src1_sel:WORD_1
    v_add_u32_sdwa v99, v83, v99 dst_sel:DWORD dst_unused:UNUSED_PAD src0_sel:DWORD src1_sel:WORD_1
    ds_write2st64_b32 v96, v32, v33 offset0:32 offset1:160
    ds_write2st64_b32 v97, v34, v35 offset0:32 offset1:160
    ds_write2st64_b32 v98, v36, v37 offset0:32 offset1:160
    ds_write2st64_b32 v99, v38, v39 offset0:32 offset1:160
    s_waitcnt lgkmcnt(12)
    v_mul_u32_u24_sdwa v84, v84, v100 dst_sel:DWORD dst_unused:UNUSED_PAD src0_sel:DWORD src1_sel:WORD_0
    v_mul_u32_u24_sdwa v85, v85, v101 dst_sel:DWORD dst_unused:UNUSED_PAD src0_sel:DWORD src1_sel:WORD_0
    v_mul_u32_u24_sdwa v86, v86, v102 dst_sel:DWORD dst_unused:UNUSED_PAD src0_sel:DWORD src1_sel:WORD_0
    v_mul_u32_u24_sdwa v87, v87, v103 dst_sel:DWORD dst_unused:UNUSED_PAD src0_sel:DWORD src1_sel:WORD_0
    v_add_u32_sdwa v100, v84, v100 dst_sel:DWORD dst_unused:UNUSED_PAD src0_sel:DWORD src1_sel:WORD_1
    v_add_u32_sdwa v101, v85, v101 dst_sel:DWORD dst_unused:UNUSED_PAD src0_sel:DWORD src1_sel:WORD_1
    v_add_u32_sdwa v102, v86, v102 dst_sel:DWORD dst_unused:UNUSED_PAD src0_sel:DWORD src1_sel:WORD_1
    v_add_u32_sdwa v103, v87, v103 dst_sel:DWORD dst_unused:UNUSED_PAD src0_sel:DWORD src1_sel:WORD_1
    ds_write2st64_b32 v100, v40, v41 offset0:32 offset1:160
    ds_write2st64_b32 v101, v42, v43 offset0:32 offset1:160
    ds_write2st64_b32 v102, v44, v45 offset0:32 offset1:160
    ds_write2st64_b32 v103, v46, v47 offset0:32 offset1:160
    s_waitcnt lgkmcnt(13)
    v_mul_u32_u24_sdwa v88, v88, v104 dst_sel:DWORD dst_unused:UNUSED_PAD src0_sel:DWORD src1_sel:WORD_0
    v_mul_u32_u24_sdwa v89, v89, v105 dst_sel:DWORD dst_unused:UNUSED_PAD src0_sel:DWORD src1_sel:WORD_0
    v_mul_u32_u24_sdwa v90, v90, v106 dst_sel:DWORD dst_unused:UNUSED_PAD src0_sel:DWORD src1_sel:WORD_0
    v_add_u32_sdwa v104, v88, v104 dst_sel:DWORD dst_unused:UNUSED_PAD src0_sel:DWORD src1_sel:WORD_1
    v_add_u32_sdwa v105, v89, v105 dst_sel:DWORD dst_unused:UNUSED_PAD src0_sel:DWORD src1_sel:WORD_1
    v_add_u32_sdwa v106, v90, v106 dst_sel:DWORD dst_unused:UNUSED_PAD src0_sel:DWORD src1_sel:WORD_1
    ds_write2st64_b32 v104, v48, v49 offset0:32 offset1:160
    ds_write2st64_b32 v105, v50, v51 offset0:32 offset1:160
    ds_write2st64_b32 v106, v52, v53 offset0:32 offset1:160
    s_waitcnt lgkmcnt(12)
    v_mul_u32_u24_sdwa v91, v91, v107 dst_sel:DWORD dst_unused:UNUSED_PAD src0_sel:DWORD src1_sel:WORD_0
    v_mul_u32_u24_sdwa v92, v92, v108 dst_sel:DWORD dst_unused:UNUSED_PAD src0_sel:DWORD src1_sel:WORD_0
    v_mul_u32_u24_sdwa v93, v93, v109 dst_sel:DWORD dst_unused:UNUSED_PAD src0_sel:DWORD src1_sel:WORD_0
    v_mul_u32_u24_sdwa v94, v94, v110 dst_sel:DWORD dst_unused:UNUSED_PAD src0_sel:DWORD src1_sel:WORD_0
    v_add_u32_sdwa v107, v91, v107 dst_sel:DWORD dst_unused:UNUSED_PAD src0_sel:DWORD src1_sel:WORD_1
    v_add_u32_sdwa v108, v92, v108 dst_sel:DWORD dst_unused:UNUSED_PAD src0_sel:DWORD src1_sel:WORD_1
    v_add_u32_sdwa v109, v93, v109 dst_sel:DWORD dst_unused:UNUSED_PAD src0_sel:DWORD src1_sel:WORD_1
    v_add_u32_sdwa v110, v94, v110 dst_sel:DWORD dst_unused:UNUSED_PAD src0_sel:DWORD src1_sel:WORD_1
    s_mov_b64 exec, s[58:59]
    ds_write2st64_b32 v107, v54, v55 offset0:32 offset1:160
    s_mov_b64 exec, s[60:61]
    ds_write2st64_b32 v108, v56, v57 offset0:32 offset1:160
    s_mov_b64 exec, s[62:63]
    ds_write2st64_b32 v109, v58, v59 offset0:32 offset1:160
    s_mov_b64 exec, s[64:65]
    ds_write2st64_b32 v110, v60, v61 offset0:32 offset1:160
    s_mov_b64 exec, -1
    s_waitcnt lgkmcnt(10)
    v_bfe_u32 v17, v17, 16, 6
    v_add_u32 v246, 128, v246
    v_add_u32 v247, 128, v247
    v_max_u32_dpp v17, v17, v17 row_shr:1 row_mask:0xf bank_mask:0xf bound_ctrl:0
    v_lshrrev_b32 v225, 3, v250
    v_and_b32 v226, 16, v250
    v_max_u32_dpp v17, v17, v17 row_shr:2 row_mask:0xf bank_mask:0xf bound_ctrl:0
    v_and_b32 v225, -4, v225
    v_lshlrev_b32 v224, 4, v226
    v_max_u32_dpp v17, v17, v17 row_shr:4 row_mask:0xf bank_mask:0xf bound_ctrl:0
    s_sub_u32 s3, s47, 528
    v_add_u32 v225, s3, v225
    v_max_u32_dpp v17, v17, v17 row_shr:8 row_mask:0xf bank_mask:0xf bound_ctrl:0
    s_nop 1
    v_max_u32_dpp v17, v17, v17 row_bcast:15 row_mask:0xa bank_mask:0xf
    ds_read2st64_b32 v[228:229], v225 offset0:0 offset1:16
    v_readlane_b32 s45, v17, 31
    v_readlane_b32 s46, v17, 63
    s_max_u32 s45, s45, 1
    s_max_u32 s46, s46, 1
    s_add_u32 s55, s45, s46
    s_mul_i32 s55, s55, -2
    s_add_i32 s55, s55, 61
    s_and_b32 s3, s2, 1
    s_mul_i32 s3, s3, 3
    s_sub_i32 s55, s55, s3
    s_max_i32 s55, s55, 0
    s_min_u32 s55, s55, s45
    s_lshl_b32 s3, s45, 7
    s_sub_u32 s6, 4224, s3
    s_mov_b32 s7, s6
    s_movk_i32 s8, 128
    s_movk_i32 s9, 128
    s_lshl_b32 s53, s41, 1
    s_add_u32 s53, s53, 5248
    s_sub_u32 s52, s45, 1
    s_sub_u32 s52, s52, 1
    s_cselect_b64 s[4:5], s[6:7], s[8:9]
    s_waitcnt vmcnt(0) lgkmcnt(0)
    s_barrier
    ds_read_b128 v[112:115], v246
    ds_read_b32 v116, v247 offset:32768
    v_lshl_add_u64 v[246:247], v[246:247], 0, s[4:5]
    ds_read_b128 v[240:243], v246
    ds_read_b32 v244, v247 offset:32768
    s_sub_u32 s52, s52, 1
    s_cselect_b64 s[4:5], s[6:7], s[8:9]
    v_lshl_add_u64 v[246:247], v[246:247], 0, s[4:5]
    s_waitcnt lgkmcnt(2)
    s_mov_b32 m0, s41
    v_mad_u32_u16 v112, v112, s40, v245
    v_mad_u32_u16 v113, v113, s40, v245
    v_mad_u32_u16 v114, v114, s40, v245
    v_mad_u32_u16 v115, v115, s40, v245
    v_add_u32 v116, v116, v248
    buffer_load_dwordx4 v112, s[12:15], s36 offen offset:0 lds
    buffer_load_dwordx4 v113, s[12:15], s37 offen offset:1056 lds
    buffer_load_dwordx4 v114, s[12:15], s38 offen offset:2112 lds
    buffer_load_dwordx4 v115, s[12:15], s39 offen offset:3168 lds
    s_add_u32 m0, s41, 4224
    s_sub_u32 s41, s53, s41
    buffer_load_dwordx4 v116, s[16:19], 0 offen lds
    ds_read_b128 v[128:131], v224 offset:6144
    ds_read_b128 v[132:135], v224 offset:6160
    ds_read_b128 v[136:139], v224 offset:6176
    ds_read_b128 v[140:143], v224 offset:6192
    ds_read_b128 v[144:147], v224 offset:6208
    ds_read_b128 v[148:151], v224 offset:6224
    ds_read_b128 v[152:155], v224 offset:6240
    ds_read_b128 v[156:159], v224 offset:6256
    ds_read_b128 v[160:163], v224 offset:6272
    ds_read_b128 v[164:167], v224 offset:6288
    ds_read_b128 v[168:171], v224 offset:6304
    ds_read_b128 v[172:175], v224 offset:6320
    ds_read_b128 v[176:179], v224 offset:6336
    ds_read_b128 v[180:183], v224 offset:6352
    ds_read_b128 v[184:187], v224 offset:6368
    ds_read_b128 v[188:191], v224 offset:6384
    v_mov_b32 v253, v228
    v_accvgpr_write_b32 a229, v229
    v_and_b32 v232, 0xffff, v228
    v_subrev_u32 v232, s29, v232
    v_min_u32 v232, 223, v232
    v_and_b32 v233, 7, v232
    v_lshl_add_u32 v232, v232, 3, v233
    v_lshlrev_b32 v232, 4, v232
    v_xor_b32 v232, v232, v226
    v_add_u32 v232, 115712, v232
    v_xor_b32 v233, 32, v232
    v_xor_b32 v234, 64, v232
    v_xor_b32 v235, 96, v232
    ds_read_b128 a[208:211], v232
    ds_read_b128 a[212:215], v233
    ds_read_b128 a[216:219], v234
    ds_read_b128 a[220:223], v235
    v_and_b32 v236, 0xffff, v229
    v_subrev_u32 v236, s29, v236
    v_min_u32 v236, 223, v236
    v_and_b32 v237, 7, v236
    v_lshl_add_u32 v236, v236, 3, v237
    v_lshlrev_b32 v236, 4, v236
    v_xor_b32 v236, v236, v226
    v_add_u32 v236, 115712, v236
    v_xor_b32 v237, 32, v236
    v_xor_b32 v238, 64, v236
    v_xor_b32 v239, 96, v236
    ds_read_b128 a[232:235], v236
    ds_read_b128 a[236:239], v237
    ds_read_b128 a[240:243], v238
    ds_read_b128 a[244:247], v239
    s_waitcnt lgkmcnt(4)
    v_mfma_f32_32x32x16_bf16 v[128:143], a[80:83], a[208:211], v[128:143]
    ds_read_b64_tr_b16 a[144:145], v204 offset:0
    ds_read_b64_tr_b16 a[146:147], v204 offset:1024
    ds_read_b64_tr_b16 a[148:149], v204 offset:2048
    ds_read_b64_tr_b16 a[150:151], v204 offset:3072
    v_mfma_f32_32x32x16_bf16 v[128:143], a[84:87], a[212:215], v[128:143]
    ds_read_b64_tr_b16 a[152:153], v204 offset:4096
    ds_read_b64_tr_b16 a[154:155], v204 offset:5120
    ds_read_b64_tr_b16 a[156:157], v204 offset:6144
    ds_read_b64_tr_b16 a[158:159], v204 offset:7168
    v_mfma_f32_32x32x16_bf16 v[128:143], a[88:91], a[216:219], v[128:143]
    ds_read_b64_tr_b16 a[160:161], v204 offset:8192
    ds_read_b64_tr_b16 a[162:163], v204 offset:9216
    ds_read_b64_tr_b16 a[164:165], v204 offset:10240
    ds_read_b64_tr_b16 a[166:167], v204 offset:11264
    v_mfma_f32_32x32x16_bf16 v[128:143], a[92:95], a[220:223], v[128:143]
    ds_read_b64_tr_b16 a[168:169], v204 offset:12288
    ds_read_b64_tr_b16 a[170:171], v204 offset:13312
    ds_read_b64_tr_b16 a[172:173], v204 offset:14336
    ds_read_b64_tr_b16 a[174:175], v204 offset:15360
    v_mfma_f32_32x32x16_bf16 v[144:159], a[96:99], a[208:211], v[144:159]
    ds_read_b64_tr_b16 a[176:177], v204 offset:32
    ds_read_b64_tr_b16 a[178:179], v204 offset:1056
    ds_read_b64_tr_b16 a[180:181], v204 offset:2080
    ds_read_b64_tr_b16 a[182:183], v204 offset:3104
    v_mfma_f32_32x32x16_bf16 v[144:159], a[100:103], a[212:215], v[144:159]
    ds_read_b64_tr_b16 a[184:185], v204 offset:4128
    ds_read_b64_tr_b16 a[186:187], v204 offset:5152
    ds_read_b64_tr_b16 a[188:189], v204 offset:6176
    ds_read_b64_tr_b16 a[190:191], v204 offset:7200
    v_mfma_f32_32x32x16_bf16 v[144:159], a[104:107], a[216:219], v[144:159]
    ds_read_b64_tr_b16 a[192:193], v204 offset:8224
    ds_read_b64_tr_b16 a[194:195], v204 offset:9248
    ds_read_b64_tr_b16 a[196:197], v204 offset:10272
    ds_read_b64_tr_b16 a[198:199], v204 offset:11296
    v_mfma_f32_32x32x16_bf16 v[144:159], a[108:111], a[220:223], v[144:159]
    ds_read_b64_tr_b16 a[200:201], v204 offset:12320
    ds_read_b64_tr_b16 a[202:203], v204 offset:13344
    ds_read_b64_tr_b16 a[204:205], v204 offset:14368
    ds_read_b64_tr_b16 a[206:207], v204 offset:15392
    v_mfma_f32_32x32x16_bf16 v[160:175], a[112:115], a[208:211], v[160:175]
    v_mfma_f32_32x32x16_bf16 v[160:175], a[116:119], a[212:215], v[160:175]
    v_mfma_f32_32x32x16_bf16 v[160:175], a[120:123], a[216:219], v[160:175]
    v_mfma_f32_32x32x16_bf16 v[160:175], a[124:127], a[220:223], v[160:175]
    v_mfma_f32_32x32x16_bf16 v[176:191], a[128:131], a[208:211], v[176:191]
    v_mfma_f32_32x32x16_bf16 v[176:191], a[132:135], a[212:215], v[176:191]
    v_mfma_f32_32x32x16_bf16 v[176:191], a[136:139], a[216:219], v[176:191]
    v_mfma_f32_32x32x16_bf16 v[176:191], a[140:143], a[220:223], v[176:191]
    s_mov_b32 m0, s41
    v_mad_u32_u16 v240, v240, s40, v245
    v_mad_u32_u16 v241, v241, s40, v245
    v_mad_u32_u16 v242, v242, s40, v245
    v_mad_u32_u16 v243, v243, s40, v245
    v_add_u32 v244, v244, v248
    buffer_load_dwordx4 v240, s[12:15], s36 offen offset:0 lds
    buffer_load_dwordx4 v241, s[12:15], s37 offen offset:1056 lds
    buffer_load_dwordx4 v242, s[12:15], s38 offen offset:2112 lds
    buffer_load_dwordx4 v243, s[12:15], s39 offen offset:3168 lds
    s_add_u32 m0, s41, 4224
    s_sub_u32 s41, s53, s41
    buffer_load_dwordx4 v244, s[16:19], 0 offen lds
    ds_read_b128 v[240:243], v246
    ds_read_b32 v244, v247 offset:32768
    s_sub_u32 s52, s52, 1
    s_cselect_b64 s[4:5], s[6:7], s[8:9]
    v_lshl_add_u64 v[246:247], v[246:247], 0, s[4:5]
    v_add_u32 v251, s41, v249
    v_add_u32 v252, s41, v250
    s_waitcnt vmcnt(5)
    ds_read_b128 a[208:211], v251 offset:0
    ds_read_b128 a[212:215], v251 offset:32
    ds_read_b128 a[216:219], v251 offset:64
    ds_read_b128 a[220:223], v251 offset:96
    ds_read_b128 a[224:227], v252
    s_waitcnt lgkmcnt(0)
    v_mfma_f32_32x32x16_bf16 v[0:15], a[0:3], a[208:211], v[128:143]
    s_mov_b32 m0, s41
    v_mad_u32_u16 v240, v240, s40, v245
    v_mad_u32_u16 v241, v241, s40, v245
    v_mfma_f32_32x32x16_bf16 v[0:15], a[4:7], a[212:215], v[0:15]
    v_mad_u32_u16 v242, v242, s40, v245
    v_mad_u32_u16 v243, v243, s40, v245
    v_add_u32 v244, v244, v248
    v_mfma_f32_32x32x16_bf16 v[0:15], a[8:11], a[216:219], v[0:15]
    buffer_load_dwordx4 v240, s[12:15], s36 offen offset:0 lds
    buffer_load_dwordx4 v241, s[12:15], s37 offen offset:1056 lds
    buffer_load_dwordx4 v242, s[12:15], s38 offen offset:2112 lds
    v_mfma_f32_32x32x16_bf16 v[0:15], a[12:15], a[220:223], v[0:15]
    buffer_load_dwordx4 v243, s[12:15], s39 offen offset:3168 lds
    s_add_u32 m0, s41, 4224
    s_sub_u32 s41, s53, s41
    v_mfma_f32_32x32x16_bf16 v[0:15], a[64:67], a[224:227], v[0:15]
    buffer_load_dwordx4 v244, s[16:19], 0 offen lds
    ds_read_b128 v[240:243], v246
    ds_read_b32 v244, v247 offset:32768
    s_sub_u32 s52, s52, 1
    s_cselect_b64 s[4:5], s[6:7], s[8:9]
    v_lshl_add_u64 v[246:247], v[246:247], 0, s[4:5]
    v_add_u32 v251, s41, v249
    v_add_u32 v252, s41, v250
.p2align 3
L_first:
    v_bfe_u32 v254, v253, 16, 6
    s_mov_b32 s44, 1
    v_mfma_f32_32x32x16_bf16 v[16:31], a[16:19], a[208:211], v[144:159]
    s_nop 0
    v_exp_f32 v64, v0
    v_exp_f32 v65, v1
    v_exp_f32 v66, v2
    v_mfma_f32_32x32x16_bf16 v[16:31], a[20:23], a[212:215], v[16:31]
    v_exp_f32 v67, v3
    v_exp_f32 v68, v4
    v_exp_f32 v69, v5
    v_mfma_f32_32x32x16_bf16 v[16:31], a[24:27], a[216:219], v[16:31]
    v_exp_f32 v70, v6
    v_exp_f32 v71, v7
    v_exp_f32 v72, v8
    v_mfma_f32_32x32x16_bf16 v[16:31], a[28:31], a[220:223], v[16:31]
    v_exp_f32 v73, v9
    v_exp_f32 v74, v10
    v_exp_f32 v75, v11
    v_mfma_f32_32x32x16_bf16 v[16:31], a[68:71], a[224:227], v[16:31]
    v_exp_f32 v76, v12
    v_exp_f32 v77, v13
    v_exp_f32 v78, v14
    v_exp_f32 v79, v15
    v_pk_add_f32 v[64:65], v[64:65], 1.0 op_sel_hi:[1,0]
    v_pk_add_f32 v[66:67], v[66:67], 1.0 op_sel_hi:[1,0]
    v_pk_add_f32 v[68:69], v[68:69], 1.0 op_sel_hi:[1,0]
    v_pk_add_f32 v[70:71], v[70:71], 1.0 op_sel_hi:[1,0]
    v_pk_add_f32 v[72:73], v[72:73], 1.0 op_sel_hi:[1,0]
    v_pk_add_f32 v[74:75], v[74:75], 1.0 op_sel_hi:[1,0]
    v_pk_add_f32 v[76:77], v[76:77], 1.0 op_sel_hi:[1,0]
    v_pk_add_f32 v[78:79], v[78:79], 1.0 op_sel_hi:[1,0]
    v_mfma_f32_32x32x16_bf16 v[32:47], a[32:35], a[208:211], v[160:175]
    v_exp_f32 v80, v16
    v_exp_f32 v81, v17
    v_exp_f32 v82, v18
    v_mfma_f32_32x32x16_bf16 v[32:47], a[36:39], a[212:215], v[32:47]
    v_exp_f32 v83, v19
    v_exp_f32 v84, v20
    v_exp_f32 v85, v21
    v_mfma_f32_32x32x16_bf16 v[32:47], a[40:43], a[216:219], v[32:47]
    v_exp_f32 v86, v22
    v_exp_f32 v87, v23
    v_exp_f32 v88, v24
    v_mfma_f32_32x32x16_bf16 v[32:47], a[44:47], a[220:223], v[32:47]
    v_exp_f32 v89, v25
    v_exp_f32 v90, v26
    v_exp_f32 v91, v27
    v_mfma_f32_32x32x16_bf16 v[32:47], a[72:75], a[224:227], v[32:47]
    v_exp_f32 v92, v28
    v_exp_f32 v93, v29
    v_exp_f32 v94, v30
    v_exp_f32 v95, v31
    v_pk_add_f32 v[80:81], v[80:81], 1.0 op_sel_hi:[1,0]
    v_pk_add_f32 v[82:83], v[82:83], 1.0 op_sel_hi:[1,0]
    v_pk_add_f32 v[84:85], v[84:85], 1.0 op_sel_hi:[1,0]
    v_pk_add_f32 v[86:87], v[86:87], 1.0 op_sel_hi:[1,0]
    v_pk_add_f32 v[88:89], v[88:89], 1.0 op_sel_hi:[1,0]
    v_pk_add_f32 v[90:91], v[90:91], 1.0 op_sel_hi:[1,0]
    v_pk_add_f32 v[92:93], v[92:93], 1.0 op_sel_hi:[1,0]
    v_pk_add_f32 v[94:95], v[94:95], 1.0 op_sel_hi:[1,0]
    v_mfma_f32_32x32x16_bf16 v[48:63], a[48:51], a[208:211], v[176:191]
    s_waitcnt vmcnt(9)
    s_cmp_eq_u32 s46, 0
    s_cbranch_scc1 L_w2
    s_waitcnt vmcnt(2)
L_w2:
    ds_read_b128 a[208:211], v251 offset:0
    v_exp_f32 v96, v32
    v_exp_f32 v97, v33
    v_exp_f32 v98, v34
    v_mfma_f32_32x32x16_bf16 v[48:63], a[52:55], a[212:215], v[48:63]
    ds_read_b128 a[212:215], v251 offset:32
    v_exp_f32 v99, v35
    v_exp_f32 v100, v36
    v_exp_f32 v101, v37
    v_mfma_f32_32x32x16_bf16 v[48:63], a[56:59], a[216:219], v[48:63]
    ds_read_b128 a[216:219], v251 offset:64
    v_exp_f32 v102, v38
    v_exp_f32 v103, v39
    v_exp_f32 v104, v40
    v_mfma_f32_32x32x16_bf16 v[48:63], a[60:63], a[220:223], v[48:63]
    ds_read_b128 a[220:223], v251 offset:96
    v_exp_f32 v105, v41
    v_exp_f32 v106, v42
    v_exp_f32 v107, v43
    v_mfma_f32_32x32x16_bf16 v[48:63], a[76:79], a[224:227], v[48:63]
    ds_read_b128 a[224:227], v252
    v_exp_f32 v108, v44
    v_exp_f32 v109, v45
    v_exp_f32 v110, v46
    v_exp_f32 v111, v47
    v_pk_add_f32 v[96:97], v[96:97], 1.0 op_sel_hi:[1,0]
    v_pk_add_f32 v[98:99], v[98:99], 1.0 op_sel_hi:[1,0]
    v_pk_add_f32 v[100:101], v[100:101], 1.0 op_sel_hi:[1,0]
    v_pk_add_f32 v[102:103], v[102:103], 1.0 op_sel_hi:[1,0]
    v_pk_add_f32 v[104:105], v[104:105], 1.0 op_sel_hi:[1,0]
    v_pk_add_f32 v[106:107], v[106:107], 1.0 op_sel_hi:[1,0]
    v_pk_add_f32 v[108:109], v[108:109], 1.0 op_sel_hi:[1,0]
    v_pk_add_f32 v[110:111], v[110:111], 1.0 op_sel_hi:[1,0]
    s_waitcnt lgkmcnt(0)
    v_mfma_f32_32x32x16_bf16 v[192:207], a[0:3], a[208:211], v[128:143]
    v_exp_f32 v112, v48
    v_exp_f32 v113, v49
    v_exp_f32 v114, v50
    v_mfma_f32_32x32x16_bf16 v[192:207], a[4:7], a[212:215], v[192:207]
    v_exp_f32 v115, v51
    v_exp_f32 v116, v52
    v_exp_f32 v117, v53
    v_mfma_f32_32x32x16_bf16 v[192:207], a[8:11], a[216:219], v[192:207]
    v_exp_f32 v118, v54
    v_exp_f32 v119, v55
    v_exp_f32 v120, v56
    v_mfma_f32_32x32x16_bf16 v[192:207], a[12:15], a[220:223], v[192:207]
    v_exp_f32 v121, v57
    v_exp_f32 v122, v58
    v_exp_f32 v123, v59
    v_mfma_f32_32x32x16_bf16 v[192:207], a[64:67], a[224:227], v[192:207]
    v_exp_f32 v124, v60
    v_exp_f32 v125, v61
    v_exp_f32 v126, v62
    v_exp_f32_e64 v127, v63
    v_pk_add_f32 v[112:113], v[112:113], 1.0 op_sel_hi:[1,0]
    v_pk_add_f32 v[114:115], v[114:115], 1.0 op_sel_hi:[1,0]
    v_pk_add_f32 v[116:117], v[116:117], 1.0 op_sel_hi:[1,0]
    v_pk_add_f32 v[118:119], v[118:119], 1.0 op_sel_hi:[1,0]
    v_pk_add_f32 v[120:121], v[120:121], 1.0 op_sel_hi:[1,0]
    v_pk_add_f32 v[122:123], v[122:123], 1.0 op_sel_hi:[1,0]
    v_pk_add_f32 v[124:125], v[124:125], 1.0 op_sel_hi:[1,0]
    v_pk_add_f32 v[126:127], v[126:127], 1.0 op_sel_hi:[1,0]
    s_cmp_ge_u32 s44, s45
    s_cbranch_scc1 L_flush
    s_sub_u32 s54, s53, s41
    s_add_u32 m0, s41, 4224
    v_add_u32 v252, s54, v250
    s_cmp_ge_u32 s44, s55
    v_mfma_f32_32x32x16_bf16 v[208:223], a[16:19], a[208:211], v[144:159]
    s_cbranch_scc1 L_row
    s_add_u32 m0, s41, 4224
.p2align 3
L_srow:
    v_exp_f32 v224, v192
    v_exp_f32 v225, v193
    v_exp_f32 v226, v194
    v_mfma_f32_32x32x16_bf16 v[208:223], a[20:23], a[212:215], v[208:223]
    s_mov_b64 exec, -1
    v_exp_f32 v227, v195
    v_exp_f32 v228, v196
    v_exp_f32 v229, v197
    v_add_u32 v244, v244, v248
    v_mad_u32_u16 v240, v240, s40, v245
    v_mad_u32_u16 v241, v241, s40, v245
    v_mfma_f32_32x32x16_bf16 v[208:223], a[24:27], a[216:219], v[208:223]
    s_sub_u32 s52, s52, 1
    v_exp_f32 v230, v198
    v_exp_f32 v231, v199
    v_exp_f32 v232, v200
    v_mad_u32_u16 v242, v242, s40, v245
    v_mad_u32_u16 v243, v243, s40, v245
    v_mfma_f32_32x32x16_bf16 v[208:223], a[28:31], a[220:223], v[208:223]
    s_cselect_b64 s[4:5], s[6:7], s[8:9]
    buffer_load_dwordx4 v244, s[16:19], 0 offen lds
    v_exp_f32 v233, v201
    v_exp_f32 v234, v202
    v_exp_f32 v235, v203
    v_mfma_f32_32x32x16_bf16 v[208:223], a[68:71], a[224:227], v[208:223]
    s_mov_b32 m0, s41
    ds_read_b32 v244, v247 offset:32768
    v_exp_f32 v236, v204
    v_exp_f32 v237, v205
    v_exp_f32 v238, v206
    v_exp_f32 v239, v207
    buffer_load_dwordx4 v240, s[12:15], s36 offen offset:0 lds
    buffer_load_dwordx4 v241, s[12:15], s37 offen offset:1056 lds
    buffer_load_dwordx4 v242, s[12:15], s38 offen offset:2112 lds
    buffer_load_dwordx4 v243, s[12:15], s39 offen offset:3168 lds
    ds_read_b128 v[240:243], v246
    v_lshl_add_u64 v[246:247], v[246:247], 0, s[4:5]
    v_cmpx_lt_u32 vcc, s44, v254
    v_pk_fma_f32 v[192:193], v[192:193], v[64:65], v[0:1]
    v_pk_fma_f32 v[64:65], v[64:65], v[224:225], v[64:65]
    v_pk_fma_f32 v[0:1], v[0:1], v[224:225], v[192:193]
    v_pk_fma_f32 v[194:195], v[194:195], v[66:67], v[2:3]
    v_pk_fma_f32 v[66:67], v[66:67], v[226:227], v[66:67]
    v_pk_fma_f32 v[2:3], v[2:3], v[226:227], v[194:195]
    v_pk_fma_f32 v[196:197], v[196:197], v[68:69], v[4:5]
    v_pk_fma_f32 v[68:69], v[68:69], v[228:229], v[68:69]
    v_pk_fma_f32 v[4:5], v[4:5], v[228:229], v[196:197]
    v_pk_fma_f32 v[198:199], v[198:199], v[70:71], v[6:7]
    v_pk_fma_f32 v[70:71], v[70:71], v[230:231], v[70:71]
    v_pk_fma_f32 v[6:7], v[6:7], v[230:231], v[198:199]
    v_pk_fma_f32 v[200:201], v[200:201], v[72:73], v[8:9]
    v_pk_fma_f32 v[72:73], v[72:73], v[232:233], v[72:73]
    v_pk_fma_f32 v[8:9], v[8:9], v[232:233], v[200:201]
    v_pk_fma_f32 v[202:203], v[202:203], v[74:75], v[10:11]
    v_pk_fma_f32 v[74:75], v[74:75], v[234:235], v[74:75]
    v_pk_fma_f32 v[10:11], v[10:11], v[234:235], v[202:203]
    v_pk_fma_f32 v[204:205], v[204:205], v[76:77], v[12:13]
    v_pk_fma_f32 v[76:77], v[76:77], v[236:237], v[76:77]
    v_pk_fma_f32 v[12:13], v[12:13], v[236:237], v[204:205]
    v_pk_fma_f32 v[206:207], v[206:207], v[78:79], v[14:15]
    v_pk_fma_f32 v[78:79], v[78:79], v[238:239], v[78:79]
    v_pk_fma_f32 v[14:15], v[14:15], v[238:239], v[206:207]
    v_mfma_f32_32x32x16_bf16 v[192:207], a[32:35], a[208:211], v[160:175]
    s_sub_u32 s41, s53, s41
    v_exp_f32 v224, v208
    v_exp_f32 v225, v209
    v_exp_f32 v226, v210
    v_mfma_f32_32x32x16_bf16 v[192:207], a[36:39], a[212:215], v[192:207]
    v_exp_f32 v227, v211
    v_exp_f32 v228, v212
    v_exp_f32 v229, v213
    v_mfma_f32_32x32x16_bf16 v[192:207], a[40:43], a[216:219], v[192:207]
    v_exp_f32 v230, v214
    v_exp_f32 v231, v215
    v_exp_f32 v232, v216
    v_mfma_f32_32x32x16_bf16 v[192:207], a[44:47], a[220:223], v[192:207]
    s_add_u32 s44, s44, 1
    v_exp_f32 v233, v217
    v_exp_f32 v234, v218
    v_exp_f32 v235, v219
    v_mfma_f32_32x32x16_bf16 v[192:207], a[72:75], a[224:227], v[192:207]
    v_exp_f32 v236, v220
    v_exp_f32 v237, v221
    v_exp_f32 v238, v222
    v_exp_f32 v239, v223
    v_add_u32_e64 v251, s41, v249
    v_pk_fma_f32 v[208:209], v[208:209], v[80:81], v[16:17]
    v_pk_fma_f32 v[80:81], v[80:81], v[224:225], v[80:81]
    v_pk_fma_f32 v[16:17], v[16:17], v[224:225], v[208:209]
    v_pk_fma_f32 v[210:211], v[210:211], v[82:83], v[18:19]
    v_pk_fma_f32 v[82:83], v[82:83], v[226:227], v[82:83]
    v_pk_fma_f32 v[18:19], v[18:19], v[226:227], v[210:211]
    v_pk_fma_f32 v[212:213], v[212:213], v[84:85], v[20:21]
    v_pk_fma_f32 v[84:85], v[84:85], v[228:229], v[84:85]
    v_pk_fma_f32 v[20:21], v[20:21], v[228:229], v[212:213]
    v_pk_fma_f32 v[214:215], v[214:215], v[86:87], v[22:23]
    v_pk_fma_f32 v[86:87], v[86:87], v[230:231], v[86:87]
    v_pk_fma_f32 v[22:23], v[22:23], v[230:231], v[214:215]
    v_pk_fma_f32 v[216:217], v[216:217], v[88:89], v[24:25]
    v_pk_fma_f32 v[88:89], v[88:89], v[232:233], v[88:89]
    v_pk_fma_f32 v[24:25], v[24:25], v[232:233], v[216:217]
    v_pk_fma_f32 v[218:219], v[218:219], v[90:91], v[26:27]
    v_pk_fma_f32 v[90:91], v[90:91], v[234:235], v[90:91]
    v_pk_fma_f32 v[26:27], v[26:27], v[234:235], v[218:219]
    v_pk_fma_f32 v[220:221], v[220:221], v[92:93], v[28:29]
    v_pk_fma_f32 v[92:93], v[92:93], v[236:237], v[92:93]
    v_pk_fma_f32 v[28:29], v[28:29], v[236:237], v[220:221]
    v_pk_fma_f32 v[222:223], v[222:223], v[94:95], v[30:31]
    v_pk_fma_f32 v[94:95], v[94:95], v[238:239], v[94:95]
    v_pk_fma_f32 v[30:31], v[30:31], v[238:239], v[222:223]
    v_mfma_f32_32x32x16_bf16 v[208:223], a[48:51], a[208:211], v[176:191]
    s_waitcnt vmcnt(4)
    ds_read_b128 a[208:211], v251 offset:0
    v_exp_f32 v224, v192
    v_exp_f32 v225, v193
    v_exp_f32 v226, v194
    v_mfma_f32_32x32x16_bf16 v[208:223], a[52:55], a[212:215], v[208:223]
    ds_read_b128 a[212:215], v251 offset:32
    v_exp_f32 v227, v195
    v_exp_f32 v228, v196
    v_exp_f32 v229, v197
    v_mfma_f32_32x32x16_bf16 v[208:223], a[56:59], a[216:219], v[208:223]
    ds_read_b128 a[216:219], v251 offset:64
    v_exp_f32 v230, v198
    v_exp_f32 v231, v199
    v_exp_f32 v232, v200
    v_mfma_f32_32x32x16_bf16 v[208:223], a[60:63], a[220:223], v[208:223]
    ds_read_b128 a[220:223], v251 offset:96
    v_exp_f32 v233, v201
    v_exp_f32 v234, v202
    v_exp_f32 v235, v203
    v_mfma_f32_32x32x16_bf16 v[208:223], a[76:79], a[224:227], v[208:223]
    s_waitcnt lgkmcnt(3)
    ds_read_b128 a[224:227], v252
    v_exp_f32 v236, v204
    v_exp_f32 v237, v205
    v_exp_f32 v238, v206
    v_exp_f32 v239, v207
    v_pk_fma_f32 v[192:193], v[192:193], v[96:97], v[32:33]
    v_pk_fma_f32 v[96:97], v[96:97], v[224:225], v[96:97]
    v_pk_fma_f32 v[32:33], v[32:33], v[224:225], v[192:193]
    v_pk_fma_f32 v[194:195], v[194:195], v[98:99], v[34:35]
    v_pk_fma_f32 v[98:99], v[98:99], v[226:227], v[98:99]
    v_pk_fma_f32 v[34:35], v[34:35], v[226:227], v[194:195]
    v_pk_fma_f32 v[196:197], v[196:197], v[100:101], v[36:37]
    v_pk_fma_f32 v[100:101], v[100:101], v[228:229], v[100:101]
    v_pk_fma_f32 v[36:37], v[36:37], v[228:229], v[196:197]
    v_pk_fma_f32 v[198:199], v[198:199], v[102:103], v[38:39]
    v_pk_fma_f32 v[102:103], v[102:103], v[230:231], v[102:103]
    v_pk_fma_f32 v[38:39], v[38:39], v[230:231], v[198:199]
    v_pk_fma_f32 v[200:201], v[200:201], v[104:105], v[40:41]
    v_pk_fma_f32 v[104:105], v[104:105], v[232:233], v[104:105]
    v_pk_fma_f32 v[40:41], v[40:41], v[232:233], v[200:201]
    v_pk_fma_f32 v[202:203], v[202:203], v[106:107], v[42:43]
    v_pk_fma_f32 v[106:107], v[106:107], v[234:235], v[106:107]
    v_pk_fma_f32 v[42:43], v[42:43], v[234:235], v[202:203]
    v_pk_fma_f32 v[204:205], v[204:205], v[108:109], v[44:45]
    v_pk_fma_f32 v[108:109], v[108:109], v[236:237], v[108:109]
    v_pk_fma_f32 v[44:45], v[44:45], v[236:237], v[204:205]
    v_pk_fma_f32 v[206:207], v[206:207], v[110:111], v[46:47]
    v_pk_fma_f32 v[110:111], v[110:111], v[238:239], v[110:111]
    v_pk_fma_f32 v[46:47], v[46:47], v[238:239], v[206:207]
    v_mfma_f32_32x32x16_bf16 v[192:207], a[0:3], a[208:211], v[128:143]
    s_waitcnt lgkmcnt(0)
    v_exp_f32 v224, v208
    v_exp_f32 v225, v209
    v_exp_f32 v226, v210
    v_mfma_f32_32x32x16_bf16 v[192:207], a[4:7], a[212:215], v[192:207]
    s_sub_u32 s54, s53, s41
    v_exp_f32 v227, v211
    v_exp_f32 v228, v212
    v_exp_f32 v229, v213
    v_mfma_f32_32x32x16_bf16 v[192:207], a[8:11], a[216:219], v[192:207]
    s_add_u32 m0, s41, 4224
    v_exp_f32 v230, v214
    v_exp_f32 v231, v215
    v_exp_f32 v232, v216
    v_mfma_f32_32x32x16_bf16 v[192:207], a[12:15], a[220:223], v[192:207]
    s_cmp_lt_u32 s44, s55
    v_exp_f32 v233, v217
    v_exp_f32 v234, v218
    v_exp_f32 v235, v219
    v_mfma_f32_32x32x16_bf16 v[192:207], a[64:67], a[224:227], v[192:207]
    v_exp_f32 v236, v220
    v_exp_f32 v237, v221
    v_exp_f32 v238, v222
    v_exp_f32 v239, v223
    v_add_u32 v252, s54, v250
    v_pk_fma_f32 v[208:209], v[208:209], v[112:113], v[48:49]
    v_pk_fma_f32 v[112:113], v[112:113], v[224:225], v[112:113]
    v_pk_fma_f32 v[48:49], v[48:49], v[224:225], v[208:209]
    v_pk_fma_f32 v[210:211], v[210:211], v[114:115], v[50:51]
    v_pk_fma_f32 v[114:115], v[114:115], v[226:227], v[114:115]
    v_pk_fma_f32 v[50:51], v[50:51], v[226:227], v[210:211]
    v_pk_fma_f32 v[212:213], v[212:213], v[116:117], v[52:53]
    v_pk_fma_f32 v[116:117], v[116:117], v[228:229], v[116:117]
    v_pk_fma_f32 v[52:53], v[52:53], v[228:229], v[212:213]
    v_pk_fma_f32 v[214:215], v[214:215], v[118:119], v[54:55]
    v_pk_fma_f32 v[118:119], v[118:119], v[230:231], v[118:119]
    v_pk_fma_f32 v[54:55], v[54:55], v[230:231], v[214:215]
    v_pk_fma_f32 v[216:217], v[216:217], v[120:121], v[56:57]
    v_pk_fma_f32 v[120:121], v[120:121], v[232:233], v[120:121]
    v_pk_fma_f32 v[56:57], v[56:57], v[232:233], v[216:217]
    v_pk_fma_f32 v[218:219], v[218:219], v[122:123], v[58:59]
    v_pk_fma_f32 v[122:123], v[122:123], v[234:235], v[122:123]
    v_pk_fma_f32 v[58:59], v[58:59], v[234:235], v[218:219]
    v_pk_fma_f32 v[220:221], v[220:221], v[124:125], v[60:61]
    v_pk_fma_f32 v[124:125], v[124:125], v[236:237], v[124:125]
    v_pk_fma_f32 v[60:61], v[60:61], v[236:237], v[220:221]
    v_pk_fma_f32 v[222:223], v[222:223], v[126:127], v[62:63]
    v_pk_fma_f32 v[126:127], v[126:127], v[238:239], v[126:127]
    v_pk_fma_f32 v[62:63], v[62:63], v[238:239], v[222:223]
    v_mfma_f32_32x32x16_bf16 v[208:223], a[16:19], a[208:211], v[144:159]
    s_cbranch_scc1 L_srow
    s_add_u32 m0, s41, 4224
    s_cmp_ge_u32 s44, s45
    s_cbranch_scc1 L_flush
.p2align 3
L_row:
    v_exp_f32 v224, v192
    v_exp_f32 v225, v193
    v_exp_f32 v226, v194
    v_mfma_f32_32x32x16_bf16 v[208:223], a[20:23], a[212:215], v[208:223]
    s_mov_b64 exec, -1
    v_exp_f32 v227, v195
    v_exp_f32 v228, v196
    v_exp_f32 v229, v197
    v_add_u32 v244, v244, v248
    v_mad_u32_u16 v240, v240, s40, v245
    v_mad_u32_u16 v241, v241, s40, v245
    v_mfma_f32_32x32x16_bf16 v[208:223], a[24:27], a[216:219], v[208:223]
    s_sub_u32 s52, s52, 1
    v_exp_f32 v230, v198
    v_exp_f32 v231, v199
    v_exp_f32 v232, v200
    v_mad_u32_u16 v242, v242, s40, v245
    v_mad_u32_u16 v243, v243, s40, v245
    v_mfma_f32_32x32x16_bf16 v[208:223], a[28:31], a[220:223], v[208:223]
    s_cselect_b64 s[4:5], s[6:7], s[8:9]
    buffer_load_dwordx4 v244, s[16:19], 0 offen lds
    v_exp_f32 v233, v201
    v_exp_f32 v234, v202
    v_exp_f32 v235, v203
    v_mfma_f32_32x32x16_bf16 v[208:223], a[68:71], a[224:227], v[208:223]
    s_mov_b32 m0, s41
    ds_read_b32 v244, v247 offset:32768
    v_exp_f32 v236, v204
    v_exp_f32 v237, v205
    v_exp_f32 v238, v206
    v_exp_f32 v239, v207
    buffer_load_dwordx4 v240, s[12:15], s36 offen offset:0 lds
    buffer_load_dwordx4 v241, s[12:15], s37 offen offset:1056 lds
    buffer_load_dwordx4 v242, s[12:15], s38 offen offset:2112 lds
    buffer_load_dwordx4 v243, s[12:15], s39 offen offset:3168 lds
    ds_read_b128 v[240:243], v246
    v_lshl_add_u64 v[246:247], v[246:247], 0, s[4:5]
    v_cmpx_lt_u32 vcc, s44, v254
    v_pk_fma_f32 v[192:193], v[192:193], v[64:65], v[0:1]
    v_pk_fma_f32 v[64:65], v[64:65], v[224:225], v[64:65]
    v_pk_fma_f32 v[0:1], v[0:1], v[224:225], v[192:193]
    v_pk_fma_f32 v[194:195], v[194:195], v[66:67], v[2:3]
    v_pk_fma_f32 v[66:67], v[66:67], v[226:227], v[66:67]
    v_pk_fma_f32 v[2:3], v[2:3], v[226:227], v[194:195]
    v_pk_fma_f32 v[196:197], v[196:197], v[68:69], v[4:5]
    v_pk_fma_f32 v[68:69], v[68:69], v[228:229], v[68:69]
    v_pk_fma_f32 v[4:5], v[4:5], v[228:229], v[196:197]
    v_pk_fma_f32 v[198:199], v[198:199], v[70:71], v[6:7]
    v_pk_fma_f32 v[70:71], v[70:71], v[230:231], v[70:71]
    v_pk_fma_f32 v[6:7], v[6:7], v[230:231], v[198:199]
    v_pk_fma_f32 v[200:201], v[200:201], v[72:73], v[8:9]
    v_pk_fma_f32 v[72:73], v[72:73], v[232:233], v[72:73]
    v_pk_fma_f32 v[8:9], v[8:9], v[232:233], v[200:201]
    v_pk_fma_f32 v[202:203], v[202:203], v[74:75], v[10:11]
    v_pk_fma_f32 v[74:75], v[74:75], v[234:235], v[74:75]
    v_pk_fma_f32 v[10:11], v[10:11], v[234:235], v[202:203]
    v_pk_fma_f32 v[204:205], v[204:205], v[76:77], v[12:13]
    v_pk_fma_f32 v[76:77], v[76:77], v[236:237], v[76:77]
    v_pk_fma_f32 v[12:13], v[12:13], v[236:237], v[204:205]
    v_pk_fma_f32 v[206:207], v[206:207], v[78:79], v[14:15]
    v_pk_fma_f32 v[78:79], v[78:79], v[238:239], v[78:79]
    v_pk_fma_f32 v[14:15], v[14:15], v[238:239], v[206:207]
    v_mfma_f32_32x32x16_bf16 v[192:207], a[32:35], a[208:211], v[160:175]
    s_sub_u32 s41, s53, s41
    v_exp_f32 v224, v208
    v_exp_f32 v225, v209
    v_exp_f32 v226, v210
    v_mfma_f32_32x32x16_bf16 v[192:207], a[36:39], a[212:215], v[192:207]
    v_exp_f32 v227, v211
    v_exp_f32 v228, v212
    v_exp_f32 v229, v213
    v_mfma_f32_32x32x16_bf16 v[192:207], a[40:43], a[216:219], v[192:207]
    v_exp_f32 v230, v214
    v_exp_f32 v231, v215
    v_exp_f32 v232, v216
    v_mfma_f32_32x32x16_bf16 v[192:207], a[44:47], a[220:223], v[192:207]
    s_add_u32 s44, s44, 1
    v_exp_f32 v233, v217
    v_exp_f32 v234, v218
    v_exp_f32 v235, v219
    v_mfma_f32_32x32x16_bf16 v[192:207], a[72:75], a[224:227], v[192:207]
    v_exp_f32 v236, v220
    v_exp_f32 v237, v221
    v_exp_f32 v238, v222
    v_exp_f32 v239, v223
    v_add_u32_e64 v251, s41, v249
    v_pk_fma_f32 v[208:209], v[208:209], v[80:81], v[16:17]
    v_pk_fma_f32 v[80:81], v[80:81], v[224:225], v[80:81]
    v_pk_fma_f32 v[16:17], v[16:17], v[224:225], v[208:209]
    v_pk_fma_f32 v[210:211], v[210:211], v[82:83], v[18:19]
    v_pk_fma_f32 v[82:83], v[82:83], v[226:227], v[82:83]
    v_pk_fma_f32 v[18:19], v[18:19], v[226:227], v[210:211]
    v_pk_fma_f32 v[212:213], v[212:213], v[84:85], v[20:21]
    v_pk_fma_f32 v[84:85], v[84:85], v[228:229], v[84:85]
    v_pk_fma_f32 v[20:21], v[20:21], v[228:229], v[212:213]
    v_pk_fma_f32 v[214:215], v[214:215], v[86:87], v[22:23]
    v_pk_fma_f32 v[86:87], v[86:87], v[230:231], v[86:87]
    v_pk_fma_f32 v[22:23], v[22:23], v[230:231], v[214:215]
    v_pk_fma_f32 v[216:217], v[216:217], v[88:89], v[24:25]
    v_pk_fma_f32 v[88:89], v[88:89], v[232:233], v[88:89]
    v_pk_fma_f32 v[24:25], v[24:25], v[232:233], v[216:217]
    v_pk_fma_f32 v[218:219], v[218:219], v[90:91], v[26:27]
    v_pk_fma_f32 v[90:91], v[90:91], v[234:235], v[90:91]
    v_pk_fma_f32 v[26:27], v[26:27], v[234:235], v[218:219]
    v_pk_fma_f32 v[220:221], v[220:221], v[92:93], v[28:29]
    v_pk_fma_f32 v[92:93], v[92:93], v[236:237], v[92:93]
    v_pk_fma_f32 v[28:29], v[28:29], v[236:237], v[220:221]
    v_pk_fma_f32 v[222:223], v[222:223], v[94:95], v[30:31]
    v_pk_fma_f32 v[94:95], v[94:95], v[238:239], v[94:95]
    v_pk_fma_f32 v[30:31], v[30:31], v[238:239], v[222:223]
    v_mfma_f32_32x32x16_bf16 v[208:223], a[48:51], a[208:211], v[176:191]
    s_waitcnt vmcnt(5)
    ds_read_b128 a[208:211], v251 offset:0
    v_exp_f32 v224, v192
    v_exp_f32 v225, v193
    v_exp_f32 v226, v194
    v_mfma_f32_32x32x16_bf16 v[208:223], a[52:55], a[212:215], v[208:223]
    ds_read_b128 a[212:215], v251 offset:32
    v_exp_f32 v227, v195
    v_exp_f32 v228, v196
    v_exp_f32 v229, v197
    v_mfma_f32_32x32x16_bf16 v[208:223], a[56:59], a[216:219], v[208:223]
    ds_read_b128 a[216:219], v251 offset:64
    v_exp_f32 v230, v198
    v_exp_f32 v231, v199
    v_exp_f32 v232, v200
    v_mfma_f32_32x32x16_bf16 v[208:223], a[60:63], a[220:223], v[208:223]
    ds_read_b128 a[220:223], v251 offset:96
    v_exp_f32 v233, v201
    v_exp_f32 v234, v202
    v_exp_f32 v235, v203
    v_mfma_f32_32x32x16_bf16 v[208:223], a[76:79], a[224:227], v[208:223]
    s_waitcnt lgkmcnt(3)
    ds_read_b128 a[224:227], v252
    v_exp_f32 v236, v204
    v_exp_f32 v237, v205
    v_exp_f32 v238, v206
    v_exp_f32 v239, v207
    v_pk_fma_f32 v[192:193], v[192:193], v[96:97], v[32:33]
    v_pk_fma_f32 v[96:97], v[96:97], v[224:225], v[96:97]
    v_pk_fma_f32 v[32:33], v[32:33], v[224:225], v[192:193]
    v_pk_fma_f32 v[194:195], v[194:195], v[98:99], v[34:35]
    v_pk_fma_f32 v[98:99], v[98:99], v[226:227], v[98:99]
    v_pk_fma_f32 v[34:35], v[34:35], v[226:227], v[194:195]
    v_pk_fma_f32 v[196:197], v[196:197], v[100:101], v[36:37]
    v_pk_fma_f32 v[100:101], v[100:101], v[228:229], v[100:101]
    v_pk_fma_f32 v[36:37], v[36:37], v[228:229], v[196:197]
    v_pk_fma_f32 v[198:199], v[198:199], v[102:103], v[38:39]
    v_pk_fma_f32 v[102:103], v[102:103], v[230:231], v[102:103]
    v_pk_fma_f32 v[38:39], v[38:39], v[230:231], v[198:199]
    v_pk_fma_f32 v[200:201], v[200:201], v[104:105], v[40:41]
    v_pk_fma_f32 v[104:105], v[104:105], v[232:233], v[104:105]
    v_pk_fma_f32 v[40:41], v[40:41], v[232:233], v[200:201]
    v_pk_fma_f32 v[202:203], v[202:203], v[106:107], v[42:43]
    v_pk_fma_f32 v[106:107], v[106:107], v[234:235], v[106:107]
    v_pk_fma_f32 v[42:43], v[42:43], v[234:235], v[202:203]
    v_pk_fma_f32 v[204:205], v[204:205], v[108:109], v[44:45]
    v_pk_fma_f32 v[108:109], v[108:109], v[236:237], v[108:109]
    v_pk_fma_f32 v[44:45], v[44:45], v[236:237], v[204:205]
    v_pk_fma_f32 v[206:207], v[206:207], v[110:111], v[46:47]
    v_pk_fma_f32 v[110:111], v[110:111], v[238:239], v[110:111]
    v_pk_fma_f32 v[46:47], v[46:47], v[238:239], v[206:207]
    v_mfma_f32_32x32x16_bf16 v[192:207], a[0:3], a[208:211], v[128:143]
    s_waitcnt lgkmcnt(0)
    v_exp_f32 v224, v208
    v_exp_f32 v225, v209
    v_exp_f32 v226, v210
    v_mfma_f32_32x32x16_bf16 v[192:207], a[4:7], a[212:215], v[192:207]
    s_sub_u32 s54, s53, s41
    v_exp_f32 v227, v211
    v_exp_f32 v228, v212
    v_exp_f32 v229, v213
    v_mfma_f32_32x32x16_bf16 v[192:207], a[8:11], a[216:219], v[192:207]
    s_add_u32 m0, s41, 4224
    v_exp_f32 v230, v214
    v_exp_f32 v231, v215
    v_exp_f32 v232, v216
    v_mfma_f32_32x32x16_bf16 v[192:207], a[12:15], a[220:223], v[192:207]
    s_cmp_lt_u32 s44, s45
    v_exp_f32 v233, v217
    v_exp_f32 v234, v218
    v_exp_f32 v235, v219
    v_mfma_f32_32x32x16_bf16 v[192:207], a[64:67], a[224:227], v[192:207]
    v_exp_f32 v236, v220
    v_exp_f32 v237, v221
    v_exp_f32 v238, v222
    v_exp_f32 v239, v223
    v_add_u32 v252, s54, v250
    v_pk_fma_f32 v[208:209], v[208:209], v[112:113], v[48:49]
    v_pk_fma_f32 v[112:113], v[112:113], v[224:225], v[112:113]
    v_pk_fma_f32 v[48:49], v[48:49], v[224:225], v[208:209]
    v_pk_fma_f32 v[210:211], v[210:211], v[114:115], v[50:51]
    v_pk_fma_f32 v[114:115], v[114:115], v[226:227], v[114:115]
    v_pk_fma_f32 v[50:51], v[50:51], v[226:227], v[210:211]
    v_pk_fma_f32 v[212:213], v[212:213], v[116:117], v[52:53]
    v_pk_fma_f32 v[116:117], v[116:117], v[228:229], v[116:117]
    v_pk_fma_f32 v[52:53], v[52:53], v[228:229], v[212:213]
    v_pk_fma_f32 v[214:215], v[214:215], v[118:119], v[54:55]
    v_pk_fma_f32 v[118:119], v[118:119], v[230:231], v[118:119]
    v_pk_fma_f32 v[54:55], v[54:55], v[230:231], v[214:215]
    v_pk_fma_f32 v[216:217], v[216:217], v[120:121], v[56:57]
    v_pk_fma_f32 v[120:121], v[120:121], v[232:233], v[120:121]
    v_pk_fma_f32 v[56:57], v[56:57], v[232:233], v[216:217]
    v_pk_fma_f32 v[218:219], v[218:219], v[122:123], v[58:59]
    v_pk_fma_f32 v[122:123], v[122:123], v[234:235], v[122:123]
    v_pk_fma_f32 v[58:59], v[58:59], v[234:235], v[218:219]
    v_pk_fma_f32 v[220:221], v[220:221], v[124:125], v[60:61]
    v_pk_fma_f32 v[124:125], v[124:125], v[236:237], v[124:125]
    v_pk_fma_f32 v[60:61], v[60:61], v[236:237], v[220:221]
    v_pk_fma_f32 v[222:223], v[222:223], v[126:127], v[62:63]
    v_pk_fma_f32 v[126:127], v[126:127], v[238:239], v[126:127]
    v_pk_fma_f32 v[62:63], v[62:63], v[238:239], v[222:223]
    v_mfma_f32_32x32x16_bf16 v[208:223], a[16:19], a[208:211], v[144:159]
    s_cbranch_scc1 L_row
L_flush:
    s_mov_b64 exec, -1
    v_and_b32 v232, 16, v250
    s_cmp_eq_u32 s46, 0
    v_lshlrev_b32 v255, 4, v232
    s_cbranch_scc1 L_last
.p2align 3
    ds_read_b128 v[128:131], v255 offset:6144
    ds_read_b128 v[132:135], v255 offset:6160
    ds_read_b128 v[136:139], v255 offset:6176
    ds_read_b128 v[140:143], v255 offset:6192
    v_add_u32 v251, s41, v249
    v_add_u32 v252, s41, v250
    v_bfe_u32 v233, v253, 22, 2
    v_lshlrev_b32 v232, 2, v232
    v_cmp_ne_u32 s[58:59], 0, v233
    v_cmp_ne_u32 s[60:61], 3, v233
    v_cmp_ne_u32 s[62:63], 0, v254
    v_mad_u32_u16 v253, v253, s40, v232
    v_cvt_f32_u32 v254, v254
    s_mov_b32 s3, 2071986176
    v_pk_mul_f32 v[224:225], v[64:65], v[66:67]
    v_pk_mul_f32 v[226:227], v[68:69], v[70:71]
    v_pk_fma_f32 v[224:225], v[72:73], v[74:75], v[224:225]
    v_pk_fma_f32 v[226:227], v[76:77], v[78:79], v[226:227]
    v_pk_fma_f32 v[224:225], v[80:81], v[82:83], v[224:225]
    v_pk_fma_f32 v[226:227], v[84:85], v[86:87], v[226:227]
    v_pk_fma_f32 v[224:225], v[88:89], v[90:91], v[224:225]
    v_pk_fma_f32 v[226:227], v[92:93], v[94:95], v[226:227]
    v_pk_fma_f32 v[224:225], v[96:97], v[98:99], v[224:225]
    v_pk_fma_f32 v[226:227], v[100:101], v[102:103], v[226:227]
    v_pk_fma_f32 v[224:225], v[104:105], v[106:107], v[224:225]
    v_pk_fma_f32 v[226:227], v[108:109], v[110:111], v[226:227]
    v_pk_fma_f32 v[224:225], v[112:113], v[114:115], v[224:225]
    v_pk_fma_f32 v[226:227], v[116:117], v[118:119], v[226:227]
    v_pk_fma_f32 v[224:225], v[120:121], v[122:123], v[224:225]
    v_pk_fma_f32 v[226:227], v[124:125], v[126:127], v[226:227]
    v_pk_add_f32 v[224:225], v[224:225], v[226:227]
    s_waitcnt lgkmcnt(0)
    v_mfma_f32_32x32x16_bf16 v[128:143], a[80:83], a[232:235], v[128:143]
    ds_read_b128 a[208:211], v251 offset:0
    ds_read_b128 a[212:215], v251 offset:32
    ds_read_b128 a[216:219], v251 offset:64
    v_rcp_f32 v64, v64
    v_rcp_f32 v65, v65
    v_rcp_f32 v66, v66
    v_rcp_f32 v67, v67
    v_add_f32 v224, v224, v225
    v_mfma_f32_32x32x16_bf16 v[128:143], a[84:87], a[236:239], v[128:143]
    ds_read_b128 a[220:223], v251 offset:96
    ds_read_b128 a[224:227], v252
    ds_read_b128 v[144:147], v255 offset:6208
    v_rcp_f32 v68, v68
    v_rcp_f32 v69, v69
    v_rcp_f32 v70, v70
    v_rcp_f32 v71, v71
    v_cmp_nge_f32 s[56:57], s3, v224
    v_mfma_f32_32x32x16_bf16 v[128:143], a[88:91], a[240:243], v[128:143]
    ds_read_b128 v[148:151], v255 offset:6224
    ds_read_b128 v[152:155], v255 offset:6240
    ds_read_b128 v[156:159], v255 offset:6256
    v_rcp_f32 v72, v72
    v_rcp_f32 v73, v73
    v_rcp_f32 v74, v74
    v_rcp_f32 v75, v75
    v_mfma_f32_32x32x16_bf16 v[128:143], a[92:95], a[244:247], v[128:143]
    ds_read_b128 v[160:163], v255 offset:6272
    ds_read_b128 v[164:167], v255 offset:6288
    ds_read_b128 v[168:171], v255 offset:6304
    v_rcp_f32 v76, v76
    v_rcp_f32 v77, v77
    v_rcp_f32 v78, v78
    v_rcp_f32 v79, v79
    v_pk_mul_f32 v[0:1], v[0:1], v[64:65]
    v_pk_mul_f32 v[2:3], v[2:3], v[66:67]
    v_pk_mul_f32 v[4:5], v[4:5], v[68:69]
    v_pk_mul_f32 v[6:7], v[6:7], v[70:71]
    v_pk_mul_f32 v[8:9], v[8:9], v[72:73]
    v_pk_mul_f32 v[10:11], v[10:11], v[74:75]
    v_pk_mul_f32 v[12:13], v[12:13], v[76:77]
    v_pk_mul_f32 v[14:15], v[14:15], v[78:79]
    s_waitcnt lgkmcnt(3)
    v_mfma_f32_32x32x16_bf16 v[144:159], a[96:99], a[232:235], v[144:159]
    s_add_u32 m0, s41, 4224
    ds_read_b128 v[172:175], v255 offset:6320
    v_cvt_pk_bf16_f32 v224, v0, v1
    v_cvt_pk_bf16_f32 v225, v2, v3
    v_cvt_pk_bf16_f32 v226, v4, v5
    v_cvt_pk_bf16_f32 v227, v6, v7
    v_add_u32 v244, v244, v248
    v_mfma_f32_32x32x16_bf16 v[144:159], a[100:103], a[236:239], v[144:159]
    buffer_load_dwordx4 v244, s[16:19], 0 offen lds
    v_cvt_pk_bf16_f32 v228, v8, v9
    v_cvt_pk_bf16_f32 v229, v10, v11
    v_cvt_pk_bf16_f32 v230, v12, v13
    v_cvt_pk_bf16_f32 v231, v14, v15
    v_mad_u32_u16 v240, v240, s40, v245
    v_mad_u32_u16 v241, v241, s40, v245
    v_mfma_f32_32x32x16_bf16 v[192:207], a[144:147], v[224:227], 0
    s_mov_b32 m0, s41
    v_rcp_f32 v80, v80
    v_rcp_f32 v81, v81
    v_mad_u32_u16 v242, v242, s40, v245
    v_mad_u32_u16 v243, v243, s40, v245
    v_mfma_f32_32x32x16_bf16 v[208:223], a[176:179], v[224:227], 0
    buffer_load_dwordx4 v240, s[12:15], s36 offen offset:0 lds
    buffer_load_dwordx4 v241, s[12:15], s37 offen offset:1056 lds
    v_rcp_f32 v82, v82
    v_rcp_f32 v83, v83
    v_mfma_f32_32x32x16_bf16 v[144:159], a[104:107], a[240:243], v[144:159]
    buffer_load_dwordx4 v242, s[12:15], s38 offen offset:2112 lds
    buffer_load_dwordx4 v243, s[12:15], s39 offen offset:3168 lds
    v_rcp_f32 v84, v84
    v_rcp_f32 v85, v85
    v_mfma_f32_32x32x16_bf16 v[192:207], a[148:151], v[228:231], v[192:207]
    s_sub_u32 s52, s52, 1
    ds_read_b128 v[240:243], v246
    ds_read_b32 v244, v247 offset:32768
    v_rcp_f32 v86, v86
    v_rcp_f32 v87, v87
    v_rcp_f32 v88, v88
    v_mfma_f32_32x32x16_bf16 v[144:159], a[108:111], a[244:247], v[144:159]
    s_cselect_b64 s[4:5], s[6:7], s[8:9]
    v_rcp_f32 v89, v89
    v_rcp_f32 v90, v90
    v_rcp_f32 v91, v91
    s_sub_u32 s41, s53, s41
    v_mfma_f32_32x32x16_bf16 v[208:223], a[180:183], v[228:231], v[208:223]
    s_waitcnt lgkmcnt(2)
    v_rcp_f32 v92, v92
    v_rcp_f32 v93, v93
    v_rcp_f32 v94, v94
    v_rcp_f32 v95, v95
    v_lshl_add_u64 v[246:247], v[246:247], 0, s[4:5]
    v_add_u32 v251, s41, v249
    v_add_u32_e64 v252, s41, v250
    v_pk_mul_f32 v[16:17], v[16:17], v[80:81]
    v_pk_mul_f32 v[18:19], v[18:19], v[82:83]
    v_pk_mul_f32 v[20:21], v[20:21], v[84:85]
    v_pk_mul_f32 v[22:23], v[22:23], v[86:87]
    v_pk_mul_f32 v[24:25], v[24:25], v[88:89]
    v_pk_mul_f32 v[26:27], v[26:27], v[90:91]
    v_pk_mul_f32 v[28:29], v[28:29], v[92:93]
    v_pk_mul_f32 v[30:31], v[30:31], v[94:95]
    v_mfma_f32_32x32x16_bf16 v[160:175], a[112:115], a[232:235], v[160:175]
    ds_read_b128 v[176:179], v255 offset:6336
    ds_read_b128 v[180:183], v255 offset:6352
    v_cvt_pk_bf16_f32 v232, v16, v17
    v_cvt_pk_bf16_f32 v233, v18, v19
    v_cvt_pk_bf16_f32 v234, v20, v21
    v_cvt_pk_bf16_f32 v235, v22, v23
    v_mfma_f32_32x32x16_bf16 v[160:175], a[116:119], a[236:239], v[160:175]
    ds_read_b128 v[184:187], v255 offset:6368
    ds_read_b128 v[188:191], v255 offset:6384
    v_cvt_pk_bf16_f32 v236, v24, v25
    v_cvt_pk_bf16_f32 v237, v26, v27
    v_cvt_pk_bf16_f32 v238, v28, v29
    v_cvt_pk_bf16_f32 v239, v30, v31
    v_mfma_f32_32x32x16_bf16 v[192:207], a[152:155], v[232:235], v[192:207]
    ds_read_b128 v[64:67], v255 offset:6656
    ds_read_b128 v[68:71], v255 offset:6672
    v_rcp_f32 v96, v96
    v_rcp_f32 v97, v97
    v_mfma_f32_32x32x16_bf16 v[208:223], a[184:187], v[232:235], v[208:223]
    ds_read_b128 v[72:75], v255 offset:6688
    ds_read_b128 v[76:79], v255 offset:6704
    v_rcp_f32 v98, v98
    v_rcp_f32 v99, v99
    v_mfma_f32_32x32x16_bf16 v[160:175], a[120:123], a[240:243], v[160:175]
    ds_read_b128 v[80:83], v255 offset:6720
    ds_read_b128 v[84:87], v255 offset:6736
    v_rcp_f32 v100, v100
    v_rcp_f32 v101, v101
    v_mfma_f32_32x32x16_bf16 v[192:207], a[156:159], v[236:239], v[192:207]
    ds_read_b128 v[88:91], v255 offset:6752
    v_rcp_f32 v102, v102
    v_rcp_f32 v103, v103
    v_rcp_f32 v104, v104
    v_mfma_f32_32x32x16_bf16 v[160:175], a[124:127], a[244:247], v[160:175]
    ds_read_b128 v[92:95], v255 offset:6768
    v_rcp_f32 v105, v105
    v_rcp_f32 v106, v106
    v_rcp_f32 v107, v107
    v_mfma_f32_32x32x16_bf16 v[208:223], a[188:191], v[236:239], v[208:223]
    s_waitcnt lgkmcnt(8)
    v_rcp_f32 v108, v108
    v_rcp_f32 v109, v109
    v_rcp_f32 v110, v110
    v_rcp_f32_e64 v111, v111
    v_pk_mul_f32 v[32:33], v[32:33], v[96:97]
    v_pk_mul_f32 v[34:35], v[34:35], v[98:99]
    v_pk_mul_f32 v[36:37], v[36:37], v[100:101]
    v_pk_mul_f32 v[38:39], v[38:39], v[102:103]
    v_pk_mul_f32 v[40:41], v[40:41], v[104:105]
    v_pk_mul_f32 v[42:43], v[42:43], v[106:107]
    v_pk_mul_f32 v[44:45], v[44:45], v[108:109]
    v_pk_mul_f32 v[46:47], v[46:47], v[110:111]
    v_mfma_f32_32x32x16_bf16 v[176:191], a[128:131], a[232:235], v[176:191]
    v_cvt_pk_bf16_f32 v224, v32, v33
    v_cvt_pk_bf16_f32 v225, v34, v35
    v_cvt_pk_bf16_f32 v226, v36, v37
    v_cvt_pk_bf16_f32 v227, v38, v39
    v_mfma_f32_32x32x16_bf16 v[176:191], a[132:135], a[236:239], v[176:191]
    s_waitcnt lgkmcnt(0)
    v_cvt_pk_bf16_f32 v228, v40, v41
    v_cvt_pk_bf16_f32 v229, v42, v43
    v_cvt_pk_bf16_f32 v230, v44, v45
    v_cvt_pk_bf16_f32 v231, v46, v47
    v_mfma_f32_32x32x16_bf16 v[192:207], a[160:163], v[224:227], v[192:207]
    v_rcp_f32 v112, v112
    v_rcp_f32 v113, v113
    v_mul_f32 v64, v64, v254
    v_mfma_f32_32x32x16_bf16 v[208:223], a[192:195], v[224:227], v[208:223]
    v_rcp_f32 v114, v114
    v_rcp_f32 v115, v115
    v_mul_f32 v65, v65, v254
    v_mfma_f32_32x32x16_bf16 v[176:191], a[136:139], a[240:243], v[176:191]
    v_rcp_f32 v116, v116
    v_rcp_f32 v117, v117
    v_mfma_f32_32x32x16_bf16 v[192:207], a[164:167], v[228:231], v[192:207]
    v_rcp_f32 v118, v118
    v_rcp_f32 v119, v119
    v_rcp_f32 v120, v120
    v_mfma_f32_32x32x16_bf16 v[176:191], a[140:143], a[244:247], v[176:191]
    v_rcp_f32 v121, v121
    v_rcp_f32 v122, v122
    v_rcp_f32 v123, v123
    v_mfma_f32_32x32x16_bf16 v[208:223], a[196:199], v[228:231], v[208:223]
    v_rcp_f32 v124, v124
    v_rcp_f32 v125, v125
    v_rcp_f32 v126, v126
    v_rcp_f32 v127, v127
    v_mul_f32 v66, v66, v254
    v_pk_mul_f32 v[48:49], v[48:49], v[112:113]
    v_pk_mul_f32 v[50:51], v[50:51], v[114:115]
    v_pk_mul_f32 v[52:53], v[52:53], v[116:117]
    v_pk_mul_f32 v[54:55], v[54:55], v[118:119]
    v_pk_mul_f32 v[56:57], v[56:57], v[120:121]
    v_pk_mul_f32 v[58:59], v[58:59], v[122:123]
    v_pk_mul_f32 v[60:61], v[60:61], v[124:125]
    v_pk_mul_f32 v[62:63], v[62:63], v[126:127]
    v_cvt_pk_bf16_f32 v232, v48, v49
    v_cvt_pk_bf16_f32 v233, v50, v51
    v_cvt_pk_bf16_f32 v234, v52, v53
    v_cvt_pk_bf16_f32 v235, v54, v55
    v_cvt_pk_bf16_f32 v236, v56, v57
    v_cvt_pk_bf16_f32 v237, v58, v59
    v_cvt_pk_bf16_f32 v238, v60, v61
    v_cvt_pk_bf16_f32 v239, v62, v63
    v_mfma_f32_32x32x16_bf16 v[192:207], a[168:171], v[232:235], v[192:207]
    s_and_b64 s[56:57], s[56:57], s[62:63]
    v_mul_f32 v67, v67, v254
    v_mul_f32 v68, v68, v254
    v_mul_f32 v69, v69, v254
    v_mul_f32 v70, v70, v254
    v_mul_f32 v71, v71, v254
    v_mul_f32 v72, v72, v254
    v_mfma_f32_32x32x16_bf16 v[208:223], a[200:203], v[232:235], v[208:223]
    s_or_b64 s[50:51], s[50:51], s[56:57]
    v_mul_f32 v73, v73, v254
    v_mul_f32 v74, v74, v254
    v_mul_f32 v75, v75, v254
    v_mul_f32 v76, v76, v254
    v_mul_f32 v77, v77, v254
    v_mul_f32 v78, v78, v254
    v_mfma_f32_32x32x16_bf16 v[192:207], a[172:175], v[236:239], v[192:207]
    s_movk_i32 s3, 0x207
    v_mul_f32 v79, v79, v254
    v_mul_f32 v80, v80, v254
    v_mul_f32 v81, v81, v254
    v_mul_f32 v82, v82, v254
    v_mul_f32 v83, v83, v254
    v_mul_f32 v84, v84, v254
    v_mfma_f32_32x32x16_bf16 v[208:223], a[204:207], v[236:239], v[208:223]
    v_mul_f32 v85, v85, v254
    v_mul_f32 v86, v86, v254
    v_mul_f32 v87, v87, v254
    v_mul_f32 v88, v88, v254
    v_mul_f32 v89, v89, v254
    v_mul_f32 v90, v90, v254
    v_mul_f32 v91, v91, v254
    v_mul_f32 v92, v92, v254
    v_mul_f32 v93, v93, v254
    v_mul_f32 v94, v94, v254
    v_mul_f32_e64 v95, v95, v254
    s_mov_b64 exec, s[62:63]
    v_pk_fma_f32 v[64:65], v[192:193], s[48:49], v[64:65]
    v_pk_fma_f32 v[66:67], v[194:195], s[48:49], v[66:67]
    v_pk_fma_f32 v[68:69], v[196:197], s[48:49], v[68:69]
    v_pk_fma_f32 v[70:71], v[198:199], s[48:49], v[70:71]
    v_pk_fma_f32 v[72:73], v[200:201], s[48:49], v[72:73]
    v_pk_fma_f32 v[74:75], v[202:203], s[48:49], v[74:75]
    v_pk_fma_f32 v[76:77], v[204:205], s[48:49], v[76:77]
    v_pk_fma_f32 v[78:79], v[206:207], s[48:49], v[78:79]
    v_pk_fma_f32 v[80:81], v[208:209], s[48:49], v[80:81]
    v_pk_fma_f32 v[82:83], v[210:211], s[48:49], v[82:83]
    v_pk_fma_f32 v[84:85], v[212:213], s[48:49], v[84:85]
    v_pk_fma_f32 v[86:87], v[214:215], s[48:49], v[86:87]
    v_pk_fma_f32 v[88:89], v[216:217], s[48:49], v[88:89]
    v_pk_fma_f32 v[90:91], v[218:219], s[48:49], v[90:91]
    v_pk_fma_f32 v[92:93], v[220:221], s[48:49], v[92:93]
    v_pk_fma_f32 v[94:95], v[222:223], s[48:49], v[94:95]
    v_cmp_class_f32_e64 vcc, v64, s3
    v_mfma_f32_32x32x16_bf16 v[0:15], a[0:3], a[208:211], v[128:143]
    s_mov_b64 exec, s[58:59]
    s_or_b64 s[50:51], s[50:51], vcc
    v_add_f32_dpp v64, v64, v64 quad_perm:[1,0,3,2] row_mask:0xf bank_mask:0xf
    v_add_f32_dpp v65, v65, v65 quad_perm:[1,0,3,2] row_mask:0xf bank_mask:0xf
    v_add_f32_dpp v66, v66, v66 quad_perm:[1,0,3,2] row_mask:0xf bank_mask:0xf
    v_add_f32_dpp v67, v67, v67 quad_perm:[1,0,3,2] row_mask:0xf bank_mask:0xf
    v_add_f32_dpp v68, v68, v68 quad_perm:[1,0,3,2] row_mask:0xf bank_mask:0xf
    v_add_f32_dpp v69, v69, v69 quad_perm:[1,0,3,2] row_mask:0xf bank_mask:0xf
    v_mfma_f32_32x32x16_bf16 v[0:15], a[4:7], a[212:215], v[0:15]
    s_mov_b32 s45, s46
    s_mov_b32 s46, 0
    v_add_f32_dpp v70, v70, v70 quad_perm:[1,0,3,2] row_mask:0xf bank_mask:0xf
    v_add_f32_dpp v71, v71, v71 quad_perm:[1,0,3,2] row_mask:0xf bank_mask:0xf
    v_add_f32_dpp v72, v72, v72 quad_perm:[1,0,3,2] row_mask:0xf bank_mask:0xf
    v_add_f32_dpp v73, v73, v73 quad_perm:[1,0,3,2] row_mask:0xf bank_mask:0xf
    v_add_f32_dpp v74, v74, v74 quad_perm:[1,0,3,2] row_mask:0xf bank_mask:0xf
    v_add_f32_dpp v75, v75, v75 quad_perm:[1,0,3,2] row_mask:0xf bank_mask:0xf
    v_mfma_f32_32x32x16_bf16 v[0:15], a[8:11], a[216:219], v[0:15]
    v_add_f32_dpp v76, v76, v76 quad_perm:[1,0,3,2] row_mask:0xf bank_mask:0xf
    v_add_f32_dpp v77, v77, v77 quad_perm:[1,0,3,2] row_mask:0xf bank_mask:0xf
    v_add_f32_dpp v78, v78, v78 quad_perm:[1,0,3,2] row_mask:0xf bank_mask:0xf
    v_add_f32_dpp v79, v79, v79 quad_perm:[1,0,3,2] row_mask:0xf bank_mask:0xf
    v_add_f32_dpp v80, v80, v80 quad_perm:[1,0,3,2] row_mask:0xf bank_mask:0xf
    v_add_f32_dpp v81, v81, v81 quad_perm:[1,0,3,2] row_mask:0xf bank_mask:0xf
    v_mfma_f32_32x32x16_bf16 v[0:15], a[12:15], a[220:223], v[0:15]
    v_add_f32_dpp v82, v82, v82 quad_perm:[1,0,3,2] row_mask:0xf bank_mask:0xf
    v_add_f32_dpp v83, v83, v83 quad_perm:[1,0,3,2] row_mask:0xf bank_mask:0xf
    v_add_f32_dpp v84, v84, v84 quad_perm:[1,0,3,2] row_mask:0xf bank_mask:0xf
    v_add_f32_dpp v85, v85, v85 quad_perm:[1,0,3,2] row_mask:0xf bank_mask:0xf
    v_add_f32_dpp v86, v86, v86 quad_perm:[1,0,3,2] row_mask:0xf bank_mask:0xf
    v_add_f32_dpp v87, v87, v87 quad_perm:[1,0,3,2] row_mask:0xf bank_mask:0xf
    v_mfma_f32_32x32x16_bf16 v[0:15], a[64:67], a[224:227], v[0:15]
    v_add_f32_dpp v88, v88, v88 quad_perm:[1,0,3,2] row_mask:0xf bank_mask:0xf
    v_add_f32_dpp v89, v89, v89 quad_perm:[1,0,3,2] row_mask:0xf bank_mask:0xf
    v_add_f32_dpp v90, v90, v90 quad_perm:[1,0,3,2] row_mask:0xf bank_mask:0xf
    v_add_f32_dpp v91, v91, v91 quad_perm:[1,0,3,2] row_mask:0xf bank_mask:0xf
    v_add_f32_dpp v92, v92, v92 quad_perm:[1,0,3,2] row_mask:0xf bank_mask:0xf
    v_add_f32_dpp v93, v93, v93 quad_perm:[1,0,3,2] row_mask:0xf bank_mask:0xf
    v_add_f32_dpp v94, v94, v94 quad_perm:[1,0,3,2] row_mask:0xf bank_mask:0xf
    v_add_f32_dpp v95, v95, v95 quad_perm:[1,0,3,2] row_mask:0xf bank_mask:0xf
    s_mov_b64 exec, s[60:61]
    s_mov_b32 s55, 0
    v_cvt_pk_bf16_f32 v224, v64, v65
    v_cvt_pk_bf16_f32 v225, v66, v67
    v_cvt_pk_bf16_f32 v226, v68, v69
    v_cvt_pk_bf16_f32 v227, v70, v71
    v_cvt_pk_bf16_f32 v228, v72, v73
    v_cvt_pk_bf16_f32 v229, v74, v75
    v_cvt_pk_bf16_f32 v230, v76, v77
    v_cvt_pk_bf16_f32 v231, v78, v79
    buffer_store_dwordx4 v[224:227], v253, s[24:27], 0 offen offset:0
    buffer_store_dwordx4 v[228:231], v253, s[24:27], 0 offen offset:16
    v_cvt_pk_bf16_f32 v232, v80, v81
    v_cvt_pk_bf16_f32 v233, v82, v83
    v_cvt_pk_bf16_f32 v234, v84, v85
    v_cvt_pk_bf16_f32 v235, v86, v87
    v_cvt_pk_bf16_f32 v236, v88, v89
    v_cvt_pk_bf16_f32 v237, v90, v91
    v_cvt_pk_bf16_f32 v238, v92, v93
    v_cvt_pk_bf16_f32 v239, v94, v95
    buffer_store_dwordx4 v[232:235], v253, s[24:27], 0 offen offset:32
    buffer_store_dwordx4 v[236:239], v253, s[24:27], 0 offen offset:48
    s_mov_b64 exec, -1
    v_accvgpr_read_b32 v253, a229
    s_branch L_first
L_last:
.p2align 3
    v_bfe_u32 v233, v253, 22, 2
    v_lshlrev_b32 v232, 2, v232
    v_cmp_ne_u32 s[58:59], 0, v233
    v_cmp_ne_u32 s[60:61], 3, v233
    v_cmp_ne_u32 s[62:63], 0, v254
    v_mad_u32_u16 v253, v253, s40, v232
    v_cvt_f32_u32 v254, v254
    s_mov_b32 s3, 2071986176
    v_pk_mul_f32 v[224:225], v[64:65], v[66:67]
    v_pk_mul_f32 v[226:227], v[68:69], v[70:71]
    v_pk_fma_f32 v[224:225], v[72:73], v[74:75], v[224:225]
    v_pk_fma_f32 v[226:227], v[76:77], v[78:79], v[226:227]
    v_pk_fma_f32 v[224:225], v[80:81], v[82:83], v[224:225]
    v_pk_fma_f32 v[226:227], v[84:85], v[86:87], v[226:227]
    v_pk_fma_f32 v[224:225], v[88:89], v[90:91], v[224:225]
    v_pk_fma_f32 v[226:227], v[92:93], v[94:95], v[226:227]
    v_pk_fma_f32 v[224:225], v[96:97], v[98:99], v[224:225]
    v_pk_fma_f32 v[226:227], v[100:101], v[102:103], v[226:227]
    v_pk_fma_f32 v[224:225], v[104:105], v[106:107], v[224:225]
    v_pk_fma_f32 v[226:227], v[108:109], v[110:111], v[226:227]
    v_pk_fma_f32 v[224:225], v[112:113], v[114:115], v[224:225]
    v_pk_fma_f32 v[226:227], v[116:117], v[118:119], v[226:227]
    v_pk_fma_f32 v[224:225], v[120:121], v[122:123], v[224:225]
    v_pk_fma_f32 v[226:227], v[124:125], v[126:127], v[226:227]
    v_pk_add_f32 v[224:225], v[224:225], v[226:227]
    v_rcp_f32 v64, v64
    v_rcp_f32 v65, v65
    v_rcp_f32 v66, v66
    v_rcp_f32 v67, v67
    v_add_f32 v224, v224, v225
    v_rcp_f32 v68, v68
    v_rcp_f32 v69, v69
    v_rcp_f32 v70, v70
    v_rcp_f32 v71, v71
    v_cmp_nge_f32 s[56:57], s3, v224
    v_rcp_f32 v72, v72
    v_rcp_f32 v73, v73
    v_rcp_f32 v74, v74
    v_rcp_f32 v75, v75
    v_rcp_f32 v76, v76
    v_rcp_f32 v77, v77
    v_rcp_f32 v78, v78
    v_rcp_f32_e64 v79, v79
    v_pk_mul_f32 v[0:1], v[0:1], v[64:65]
    v_pk_mul_f32 v[2:3], v[2:3], v[66:67]
    v_pk_mul_f32 v[4:5], v[4:5], v[68:69]
    v_pk_mul_f32 v[6:7], v[6:7], v[70:71]
    v_pk_mul_f32 v[8:9], v[8:9], v[72:73]
    v_pk_mul_f32 v[10:11], v[10:11], v[74:75]
    v_pk_mul_f32 v[12:13], v[12:13], v[76:77]
    v_pk_mul_f32 v[14:15], v[14:15], v[78:79]
    v_cvt_pk_bf16_f32 v224, v0, v1
    v_cvt_pk_bf16_f32 v225, v2, v3
    v_cvt_pk_bf16_f32 v226, v4, v5
    v_cvt_pk_bf16_f32 v227, v6, v7
    v_cvt_pk_bf16_f32 v228, v8, v9
    v_cvt_pk_bf16_f32 v229, v10, v11
    v_cvt_pk_bf16_f32 v230, v12, v13
    v_cvt_pk_bf16_f32 v231, v14, v15
    v_mfma_f32_32x32x16_bf16 v[192:207], a[144:147], v[224:227], 0
    v_rcp_f32 v80, v80
    v_rcp_f32 v81, v81
    v_rcp_f32 v82, v82
    v_rcp_f32 v83, v83
    v_mfma_f32_32x32x16_bf16 v[208:223], a[176:179], v[224:227], 0
    v_rcp_f32 v84, v84
    v_rcp_f32 v85, v85
    v_rcp_f32 v86, v86
    v_rcp_f32 v87, v87
    v_mfma_f32_32x32x16_bf16 v[192:207], a[148:151], v[228:231], v[192:207]
    v_rcp_f32 v88, v88
    v_rcp_f32 v89, v89
    v_rcp_f32 v90, v90
    v_rcp_f32 v91, v91
    v_mfma_f32_32x32x16_bf16 v[208:223], a[180:183], v[228:231], v[208:223]
    v_rcp_f32 v92, v92
    v_rcp_f32 v93, v93
    v_rcp_f32 v94, v94
    v_rcp_f32 v95, v95
    v_pk_mul_f32 v[16:17], v[16:17], v[80:81]
    v_pk_mul_f32 v[18:19], v[18:19], v[82:83]
    v_pk_mul_f32 v[20:21], v[20:21], v[84:85]
    v_pk_mul_f32 v[22:23], v[22:23], v[86:87]
    v_pk_mul_f32 v[24:25], v[24:25], v[88:89]
    v_pk_mul_f32 v[26:27], v[26:27], v[90:91]
    v_pk_mul_f32 v[28:29], v[28:29], v[92:93]
    v_pk_mul_f32 v[30:31], v[30:31], v[94:95]
    v_cvt_pk_bf16_f32 v232, v16, v17
    v_cvt_pk_bf16_f32 v233, v18, v19
    v_cvt_pk_bf16_f32 v234, v20, v21
    v_cvt_pk_bf16_f32 v235, v22, v23
    v_cvt_pk_bf16_f32 v236, v24, v25
    v_cvt_pk_bf16_f32 v237, v26, v27
    v_cvt_pk_bf16_f32 v238, v28, v29
    v_cvt_pk_bf16_f32 v239, v30, v31
    v_mfma_f32_32x32x16_bf16 v[192:207], a[152:155], v[232:235], v[192:207]
    ds_read_b128 v[64:67], v255 offset:6656
    ds_read_b128 v[68:71], v255 offset:6672
    v_rcp_f32 v96, v96
    v_rcp_f32 v97, v97
    v_rcp_f32 v98, v98
    v_rcp_f32 v99, v99
    v_mfma_f32_32x32x16_bf16 v[208:223], a[184:187], v[232:235], v[208:223]
    ds_read_b128 v[72:75], v255 offset:6688
    ds_read_b128 v[76:79], v255 offset:6704
    v_rcp_f32 v100, v100
    v_rcp_f32 v101, v101
    v_rcp_f32 v102, v102
    v_rcp_f32 v103, v103
    v_mfma_f32_32x32x16_bf16 v[192:207], a[156:159], v[236:239], v[192:207]
    ds_read_b128 v[80:83], v255 offset:6720
    ds_read_b128 v[84:87], v255 offset:6736
    v_rcp_f32 v104, v104
    v_rcp_f32 v105, v105
    v_rcp_f32 v106, v106
    v_rcp_f32 v107, v107
    v_mfma_f32_32x32x16_bf16 v[208:223], a[188:191], v[236:239], v[208:223]
    ds_read_b128 v[88:91], v255 offset:6752
    ds_read_b128 v[92:95], v255 offset:6768
    v_rcp_f32 v108, v108
    v_rcp_f32 v109, v109
    v_rcp_f32 v110, v110
    v_rcp_f32 v111, v111
    v_pk_mul_f32 v[32:33], v[32:33], v[96:97]
    v_pk_mul_f32 v[34:35], v[34:35], v[98:99]
    v_pk_mul_f32 v[36:37], v[36:37], v[100:101]
    v_pk_mul_f32 v[38:39], v[38:39], v[102:103]
    v_pk_mul_f32 v[40:41], v[40:41], v[104:105]
    v_pk_mul_f32 v[42:43], v[42:43], v[106:107]
    v_pk_mul_f32 v[44:45], v[44:45], v[108:109]
    v_pk_mul_f32 v[46:47], v[46:47], v[110:111]
    v_cvt_pk_bf16_f32 v224, v32, v33
    v_cvt_pk_bf16_f32 v225, v34, v35
    v_cvt_pk_bf16_f32 v226, v36, v37
    v_cvt_pk_bf16_f32 v227, v38, v39
    v_cvt_pk_bf16_f32 v228, v40, v41
    v_cvt_pk_bf16_f32 v229, v42, v43
    v_cvt_pk_bf16_f32 v230, v44, v45
    v_cvt_pk_bf16_f32 v231, v46, v47
    v_mfma_f32_32x32x16_bf16 v[192:207], a[160:163], v[224:227], v[192:207]
    v_rcp_f32 v112, v112
    v_rcp_f32 v113, v113
    v_rcp_f32 v114, v114
    v_rcp_f32 v115, v115
    v_mfma_f32_32x32x16_bf16 v[208:223], a[192:195], v[224:227], v[208:223]
    s_waitcnt lgkmcnt(0)
    v_rcp_f32 v116, v116
    v_rcp_f32 v117, v117
    v_rcp_f32 v118, v118
    v_rcp_f32 v119, v119
    v_mfma_f32_32x32x16_bf16 v[192:207], a[164:167], v[228:231], v[192:207]
    v_rcp_f32 v120, v120
    v_rcp_f32 v121, v121
    v_rcp_f32 v122, v122
    v_rcp_f32 v123, v123
    v_mfma_f32_32x32x16_bf16 v[208:223], a[196:199], v[228:231], v[208:223]
    v_rcp_f32 v124, v124
    v_rcp_f32 v125, v125
    v_rcp_f32 v126, v126
    v_rcp_f32 v127, v127
    v_mul_f32 v64, v64, v254
    v_mul_f32 v65, v65, v254
    v_mul_f32 v66, v66, v254
    v_pk_mul_f32 v[48:49], v[48:49], v[112:113]
    v_pk_mul_f32 v[50:51], v[50:51], v[114:115]
    v_pk_mul_f32 v[52:53], v[52:53], v[116:117]
    v_pk_mul_f32 v[54:55], v[54:55], v[118:119]
    v_pk_mul_f32 v[56:57], v[56:57], v[120:121]
    v_pk_mul_f32 v[58:59], v[58:59], v[122:123]
    v_pk_mul_f32 v[60:61], v[60:61], v[124:125]
    v_pk_mul_f32 v[62:63], v[62:63], v[126:127]
    v_cvt_pk_bf16_f32 v232, v48, v49
    v_cvt_pk_bf16_f32 v233, v50, v51
    v_cvt_pk_bf16_f32 v234, v52, v53
    v_cvt_pk_bf16_f32 v235, v54, v55
    v_cvt_pk_bf16_f32 v236, v56, v57
    v_cvt_pk_bf16_f32 v237, v58, v59
    v_cvt_pk_bf16_f32 v238, v60, v61
    v_cvt_pk_bf16_f32 v239, v62, v63
    v_mfma_f32_32x32x16_bf16 v[192:207], a[168:171], v[232:235], v[192:207]
    s_and_b64 s[56:57], s[56:57], s[62:63]
    v_mul_f32 v67, v67, v254
    v_mul_f32 v68, v68, v254
    v_mul_f32 v69, v69, v254
    v_mul_f32 v70, v70, v254
    v_mul_f32 v71, v71, v254
    v_mul_f32 v72, v72, v254
    v_mfma_f32_32x32x16_bf16 v[208:223], a[200:203], v[232:235], v[208:223]
    s_or_b64 s[50:51], s[50:51], s[56:57]
    v_mul_f32 v73, v73, v254
    v_mul_f32 v74, v74, v254
    v_mul_f32 v75, v75, v254
    v_mul_f32 v76, v76, v254
    v_mul_f32 v77, v77, v254
    v_mul_f32 v78, v78, v254
    v_mfma_f32_32x32x16_bf16 v[192:207], a[172:175], v[236:239], v[192:207]
    s_movk_i32 s3, 0x207
    v_mul_f32 v79, v79, v254
    v_mul_f32 v80, v80, v254
    v_mul_f32 v81, v81, v254
    v_mul_f32 v82, v82, v254
    v_mul_f32 v83, v83, v254
    v_mul_f32 v84, v84, v254
    v_mfma_f32_32x32x16_bf16 v[208:223], a[204:207], v[236:239], v[208:223]
    v_mul_f32 v85, v85, v254
    v_mul_f32 v86, v86, v254
    v_mul_f32 v87, v87, v254
    v_mul_f32 v88, v88, v254
    v_mul_f32 v89, v89, v254
    v_mul_f32 v90, v90, v254
    v_mul_f32 v91, v91, v254
    v_mul_f32 v92, v92, v254
    v_mul_f32 v93, v93, v254
    v_mul_f32 v94, v94, v254
    v_mul_f32_e64 v95, v95, v254
    s_mov_b64 exec, s[62:63]
    v_pk_fma_f32 v[64:65], v[192:193], s[48:49], v[64:65]
    v_pk_fma_f32 v[66:67], v[194:195], s[48:49], v[66:67]
    v_pk_fma_f32 v[68:69], v[196:197], s[48:49], v[68:69]
    v_pk_fma_f32 v[70:71], v[198:199], s[48:49], v[70:71]
    v_pk_fma_f32 v[72:73], v[200:201], s[48:49], v[72:73]
    v_pk_fma_f32 v[74:75], v[202:203], s[48:49], v[74:75]
    v_pk_fma_f32 v[76:77], v[204:205], s[48:49], v[76:77]
    v_pk_fma_f32 v[78:79], v[206:207], s[48:49], v[78:79]
    v_pk_fma_f32 v[80:81], v[208:209], s[48:49], v[80:81]
    v_pk_fma_f32 v[82:83], v[210:211], s[48:49], v[82:83]
    v_pk_fma_f32 v[84:85], v[212:213], s[48:49], v[84:85]
    v_pk_fma_f32 v[86:87], v[214:215], s[48:49], v[86:87]
    v_pk_fma_f32 v[88:89], v[216:217], s[48:49], v[88:89]
    v_pk_fma_f32 v[90:91], v[218:219], s[48:49], v[90:91]
    v_pk_fma_f32 v[92:93], v[220:221], s[48:49], v[92:93]
    v_pk_fma_f32 v[94:95], v[222:223], s[48:49], v[94:95]
    v_cmp_class_f32_e64 vcc, v64, s3
    s_mov_b64 exec, s[58:59]
    s_or_b64 s[50:51], s[50:51], vcc
    v_add_f32_dpp v64, v64, v64 quad_perm:[1,0,3,2] row_mask:0xf bank_mask:0xf
    v_add_f32_dpp v65, v65, v65 quad_perm:[1,0,3,2] row_mask:0xf bank_mask:0xf
    v_add_f32_dpp v66, v66, v66 quad_perm:[1,0,3,2] row_mask:0xf bank_mask:0xf
    v_add_f32_dpp v67, v67, v67 quad_perm:[1,0,3,2] row_mask:0xf bank_mask:0xf
    v_add_f32_dpp v68, v68, v68 quad_perm:[1,0,3,2] row_mask:0xf bank_mask:0xf
    v_add_f32_dpp v69, v69, v69 quad_perm:[1,0,3,2] row_mask:0xf bank_mask:0xf
    v_add_f32_dpp v70, v70, v70 quad_perm:[1,0,3,2] row_mask:0xf bank_mask:0xf
    v_add_f32_dpp v71, v71, v71 quad_perm:[1,0,3,2] row_mask:0xf bank_mask:0xf
    v_add_f32_dpp v72, v72, v72 quad_perm:[1,0,3,2] row_mask:0xf bank_mask:0xf
    v_add_f32_dpp v73, v73, v73 quad_perm:[1,0,3,2] row_mask:0xf bank_mask:0xf
    v_add_f32_dpp v74, v74, v74 quad_perm:[1,0,3,2] row_mask:0xf bank_mask:0xf
    v_add_f32_dpp v75, v75, v75 quad_perm:[1,0,3,2] row_mask:0xf bank_mask:0xf
    v_add_f32_dpp v76, v76, v76 quad_perm:[1,0,3,2] row_mask:0xf bank_mask:0xf
    v_add_f32_dpp v77, v77, v77 quad_perm:[1,0,3,2] row_mask:0xf bank_mask:0xf
    v_add_f32_dpp v78, v78, v78 quad_perm:[1,0,3,2] row_mask:0xf bank_mask:0xf
    v_add_f32_dpp v79, v79, v79 quad_perm:[1,0,3,2] row_mask:0xf bank_mask:0xf
    v_add_f32_dpp v80, v80, v80 quad_perm:[1,0,3,2] row_mask:0xf bank_mask:0xf
    v_add_f32_dpp v81, v81, v81 quad_perm:[1,0,3,2] row_mask:0xf bank_mask:0xf
    v_add_f32_dpp v82, v82, v82 quad_perm:[1,0,3,2] row_mask:0xf bank_mask:0xf
    v_add_f32_dpp v83, v83, v83 quad_perm:[1,0,3,2] row_mask:0xf bank_mask:0xf
    v_add_f32_dpp v84, v84, v84 quad_perm:[1,0,3,2] row_mask:0xf bank_mask:0xf
    v_add_f32_dpp v85, v85, v85 quad_perm:[1,0,3,2] row_mask:0xf bank_mask:0xf
    v_add_f32_dpp v86, v86, v86 quad_perm:[1,0,3,2] row_mask:0xf bank_mask:0xf
    v_add_f32_dpp v87, v87, v87 quad_perm:[1,0,3,2] row_mask:0xf bank_mask:0xf
    v_add_f32_dpp v88, v88, v88 quad_perm:[1,0,3,2] row_mask:0xf bank_mask:0xf
    v_add_f32_dpp v89, v89, v89 quad_perm:[1,0,3,2] row_mask:0xf bank_mask:0xf
    v_add_f32_dpp v90, v90, v90 quad_perm:[1,0,3,2] row_mask:0xf bank_mask:0xf
    v_add_f32_dpp v91, v91, v91 quad_perm:[1,0,3,2] row_mask:0xf bank_mask:0xf
    v_add_f32_dpp v92, v92, v92 quad_perm:[1,0,3,2] row_mask:0xf bank_mask:0xf
    v_add_f32_dpp v93, v93, v93 quad_perm:[1,0,3,2] row_mask:0xf bank_mask:0xf
    v_add_f32_dpp v94, v94, v94 quad_perm:[1,0,3,2] row_mask:0xf bank_mask:0xf
    v_add_f32_dpp v95, v95, v95 quad_perm:[1,0,3,2] row_mask:0xf bank_mask:0xf
    s_mov_b64 exec, s[60:61]
    s_mov_b32 s55, 0
    v_cvt_pk_bf16_f32 v224, v64, v65
    v_cvt_pk_bf16_f32 v225, v66, v67
    v_cvt_pk_bf16_f32 v226, v68, v69
    v_cvt_pk_bf16_f32 v227, v70, v71
    v_cvt_pk_bf16_f32 v228, v72, v73
    v_cvt_pk_bf16_f32 v229, v74, v75
    v_cvt_pk_bf16_f32 v230, v76, v77
    v_cvt_pk_bf16_f32 v231, v78, v79
    buffer_store_dwordx4 v[224:227], v253, s[24:27], 0 offen offset:0
    buffer_store_dwordx4 v[228:231], v253, s[24:27], 0 offen offset:16
    v_cvt_pk_bf16_f32 v232, v80, v81
    v_cvt_pk_bf16_f32 v233, v82, v83
    v_cvt_pk_bf16_f32 v234, v84, v85
    v_cvt_pk_bf16_f32 v235, v86, v87
    v_cvt_pk_bf16_f32 v236, v88, v89
    v_cvt_pk_bf16_f32 v237, v90, v91
    v_cvt_pk_bf16_f32 v238, v92, v93
    v_cvt_pk_bf16_f32 v239, v94, v95
    buffer_store_dwordx4 v[232:235], v253, s[24:27], 0 offen offset:32
    buffer_store_dwordx4 v[236:239], v253, s[24:27], 0 offen offset:48
    s_mov_b64 exec, -1
    s_cmp_eq_u64 s[50:51], 0
    v_mov_b32 v1, 0
    v_mov_b32 v2, 1
    s_cbranch_scc1 L_nobad
    ds_write_b32 v1, v2 offset:5376
L_nobad:
    s_waitcnt lgkmcnt(0)
    s_barrier
    ds_read_b32 v2, v1 offset:5376
    s_waitcnt lgkmcnt(0)
    v_readfirstlane_b32 s3, v2
    s_cmp_lg_u32 s3, 0
    s_cbranch_scc1 L_slow
L_end:
    s_endpgm
L_retry0:
    buffer_load_dwordx2 v[32:33], v144, s[20:23], 0 offen offset:0 sc1
    buffer_load_dwordx2 v[34:35], v145, s[20:23], 0 offen offset:512 sc1
    buffer_load_dwordx2 v[36:37], v146, s[20:23], 0 offen offset:1024 sc1
    buffer_load_dwordx2 v[38:39], v147, s[20:23], 0 offen offset:1536 sc1
    s_waitcnt vmcnt(0)
    s_sub_u32 s67, s67, 1
    s_cbranch_scc0 L_chk0
    s_mov_b32 s66, 1
    s_branch L_skipB
L_retry1:
    buffer_load_dwordx2 v[40:41], v148, s[20:23], 0 offen offset:2048 sc1
    buffer_load_dwordx2 v[42:43], v149, s[20:23], 0 offen offset:2560 sc1
    buffer_load_dwordx2 v[44:45], v150, s[20:23], 0 offen offset:3072 sc1
    buffer_load_dwordx2 v[46:47], v151, s[20:23], 0 offen offset:3584 sc1
    s_waitcnt vmcnt(0)
    s_sub_u32 s67, s67, 1
    s_cbranch_scc0 L_chk1
    s_mov_b32 s66, 1
    s_branch L_skipB
L_retry2:
    buffer_load_dwordx2 v[48:49], v152, s[20:23], s34 offen offset:0 sc1
    buffer_load_dwordx2 v[50:51], v153, s[20:23], s34 offen offset:512 sc1
    buffer_load_dwordx2 v[52:53], v154, s[20:23], s34 offen offset:1024 sc1
    s_waitcnt vmcnt(0)
    s_sub_u32 s67, s67, 1
    s_cbranch_scc0 L_chk2
    s_mov_b32 s66, 1
    s_branch L_skipB
L_retry3:
    buffer_load_dwordx2 v[54:55], v155, s[20:23], s34 offen offset:1536 sc1
    buffer_load_dwordx2 v[56:57], v156, s[20:23], s34 offen offset:2048 sc1
    buffer_load_dwordx2 v[58:59], v157, s[20:23], s34 offen offset:2560 sc1
    buffer_load_dwordx2 v[60:61], v158, s[20:23], s34 offen offset:3072 sc1
    s_waitcnt vmcnt(0)
    s_sub_u32 s67, s67, 1
    s_cbranch_scc0 L_chk3
    s_mov_b32 s66, 1
    s_branch L_skipB
L_slow0:
    s_waitcnt vmcnt(0)
    s_barrier
    ds_read_b64_tr_b16 a[144:145], v204 offset:0
    ds_read_b64_tr_b16 a[146:147], v204 offset:1024
    ds_read_b64_tr_b16 a[148:149], v204 offset:2048
    ds_read_b64_tr_b16 a[150:151], v204 offset:3072
    ds_read_b64_tr_b16 a[152:153], v204 offset:4096
    ds_read_b64_tr_b16 a[154:155], v204 offset:5120
    ds_read_b64_tr_b16 a[156:157], v204 offset:6144
    ds_read_b64_tr_b16 a[158:159], v204 offset:7168
    ds_read_b64_tr_b16 a[160:161], v204 offset:8192
    ds_read_b64_tr_b16 a[162:163], v204 offset:9216
    ds_read_b64_tr_b16 a[164:165], v204 offset:10240
    ds_read_b64_tr_b16 a[166:167], v204 offset:11264
    ds_read_b64_tr_b16 a[168:169], v204 offset:12288
    ds_read_b64_tr_b16 a[170:171], v204 offset:13312
    ds_read_b64_tr_b16 a[172:173], v204 offset:14336
    ds_read_b64_tr_b16 a[174:175], v204 offset:15360
    ds_read_b64_tr_b16 a[176:177], v204 offset:32
    ds_read_b64_tr_b16 a[178:179], v204 offset:1056
    ds_read_b64_tr_b16 a[180:181], v204 offset:2080
    ds_read_b64_tr_b16 a[182:183], v204 offset:3104
    ds_read_b64_tr_b16 a[184:185], v204 offset:4128
    ds_read_b64_tr_b16 a[186:187], v204 offset:5152
    ds_read_b64_tr_b16 a[188:189], v204 offset:6176
    ds_read_b64_tr_b16 a[190:191], v204 offset:7200
    ds_read_b64_tr_b16 a[192:193], v204 offset:8224
    ds_read_b64_tr_b16 a[194:195], v204 offset:9248
    ds_read_b64_tr_b16 a[196:197], v204 offset:10272
    ds_read_b64_tr_b16 a[198:199], v204 offset:11296
    ds_read_b64_tr_b16 a[200:201], v204 offset:12320
    ds_read_b64_tr_b16 a[202:203], v204 offset:13344
    ds_read_b64_tr_b16 a[204:205], v204 offset:14368
    ds_read_b64_tr_b16 a[206:207], v204 offset:15392
L_slow:
    s_mov_b64 exec, -1
    s_waitcnt vmcnt(0) lgkmcnt(0)
    s_load_dwordx4 s[8:11], s[0:1], 16
    s_barrier
    v_mbcnt_lo_u32_b32 v240, -1, 0
    v_mbcnt_hi_u32_b32 v240, -1, v240
    v_and_b32 v241, 31, v240
    v_lshrrev_b32 v242, 5, v240
    s_lshl_b32 s3, s31, 10
    v_lshl_add_u32 v4, v240, 4, s3
    v_mov_b32 v0, 0
    v_mov_b32 v1, 0
    v_mov_b32 v2, 0
    v_mov_b32 v3, 0
    ds_write_b128 v4, v[0:3] offset:8192
    ds_write_b128 v4, v[0:3] offset:12288
    ds_write_b128 v4, v[0:3] offset:16384
    ds_write_b128 v4, v[0:3] offset:20480
    ds_write_b128 v4, v[0:3] offset:24576
    ds_write_b128 v4, v[0:3] offset:28672
    ds_write_b128 v4, v[0:3] offset:32768
    ds_write_b128 v4, v[0:3] offset:36864
    ds_write_b128 v4, v[0:3] offset:40960
    ds_write_b128 v4, v[0:3] offset:45056
    ds_write_b128 v4, v[0:3] offset:49152
    ds_write_b128 v4, v[0:3] offset:53248
    ds_write_b128 v4, v[0:3] offset:57344
    s_waitcnt lgkmcnt(0)
    s_barrier
    s_mov_b32 s68, s10
    s_and_b32 s69, s11, 0xffff
    s_mov_b32 s70, 3200000
    s_mov_b32 s71, 0x20000
    s_mov_b32 s72, s8
    s_and_b32 s73, s9, 0xffff
    s_mov_b32 s74, 3200000
    s_mov_b32 s75, 0x20000
    s_lshl_b32 s56, s31, 9
    v_lshlrev_b32 v243, 4, v241
L_s_blk:
    buffer_load_dwordx4 v[252:255], v243, s[68:71], s56 offen
    s_mov_b32 s57, 0
    s_waitcnt vmcnt(0)
L_s_sub:
    v_subrev_u32 v248, s29, v252
    v_cmp_gt_u32 s[60:61], s30, v248
    s_cmp_eq_u64 s[60:61], 0
    s_cbranch_scc1 L_s_next
    s_add_u32 s3, s56, s57
    buffer_load_dword v244, v243, s[72:75], s3 offen
    v_lshlrev_b32 v247, 8, v242
    ds_read_b128 v[128:131], v247 offset:6144
    ds_read_b128 v[132:135], v247 offset:6160
    ds_read_b128 v[136:139], v247 offset:6176
    ds_read_b128 v[140:143], v247 offset:6192
    ds_read_b128 v[144:147], v247 offset:6208
    ds_read_b128 v[148:151], v247 offset:6224
    ds_read_b128 v[152:155], v247 offset:6240
    ds_read_b128 v[156:159], v247 offset:6256
    ds_read_b128 v[160:163], v247 offset:6272
    ds_read_b128 v[164:167], v247 offset:6288
    ds_read_b128 v[168:171], v247 offset:6304
    ds_read_b128 v[172:175], v247 offset:6320
    ds_read_b128 v[176:179], v247 offset:6336
    ds_read_b128 v[180:183], v247 offset:6352
    ds_read_b128 v[184:187], v247 offset:6368
    ds_read_b128 v[188:191], v247 offset:6384
    v_lshlrev_b32 v247, 4, v242
    v_add_lshl_u32 v245, v243, s3, 3
    v_add_u32 v245, v245, v247
    v_lshl_add_u32 v249, v252, 7, v247
    v_mul_u32_u24 v246, 260, v248
    v_lshl_add_u32 v246, v242, 7, v246
    s_waitcnt vmcnt(0)
    v_lshl_add_u32 v244, v244, 7, v247
    s_mov_b64 exec, s[60:61]
    buffer_load_dwordx4 a[208:211], v244, s[12:15], s36 offen offset:0
    buffer_load_dwordx4 a[212:215], v244, s[12:15], s36 offen offset:32
    buffer_load_dwordx4 a[216:219], v244, s[12:15], s36 offen offset:64
    buffer_load_dwordx4 a[220:223], v244, s[12:15], s36 offen offset:96
    buffer_load_dwordx4 a[224:227], v245, s[16:19], 0 offen
    buffer_load_dwordx4 v[224:227], v249, s[12:15], s36 offen offset:0
    buffer_load_dwordx4 v[228:231], v249, s[12:15], s36 offen offset:32
    buffer_load_dwordx4 v[232:235], v249, s[12:15], s36 offen offset:64
    buffer_load_dwordx4 v[236:239], v249, s[12:15], s36 offen offset:96
    s_waitcnt vmcnt(0) lgkmcnt(0)
    v_mfma_f32_32x32x16_bf16 v[128:143], a[80:83], v[224:227], v[128:143]
    v_mfma_f32_32x32x16_bf16 v[128:143], a[84:87], v[228:231], v[128:143]
    v_mfma_f32_32x32x16_bf16 v[128:143], a[88:91], v[232:235], v[128:143]
    v_mfma_f32_32x32x16_bf16 v[128:143], a[92:95], v[236:239], v[128:143]
    v_mfma_f32_32x32x16_bf16 v[128:143], a[0:3], a[208:211], v[128:143]
    v_mfma_f32_32x32x16_bf16 v[128:143], a[4:7], a[212:215], v[128:143]
    v_mfma_f32_32x32x16_bf16 v[128:143], a[8:11], a[216:219], v[128:143]
    v_mfma_f32_32x32x16_bf16 v[128:143], a[12:15], a[220:223], v[128:143]
    v_mfma_f32_32x32x16_bf16 v[128:143], a[64:67], a[224:227], v[128:143]
    v_mfma_f32_32x32x16_bf16 v[144:159], a[96:99], v[224:227], v[144:159]
    v_mfma_f32_32x32x16_bf16 v[144:159], a[100:103], v[228:231], v[144:159]
    v_mfma_f32_32x32x16_bf16 v[144:159], a[104:107], v[232:235], v[144:159]
    v_mfma_f32_32x32x16_bf16 v[144:159], a[108:111], v[236:239], v[144:159]
    v_mfma_f32_32x32x16_bf16 v[144:159], a[16:19], a[208:211], v[144:159]
    v_mfma_f32_32x32x16_bf16 v[144:159], a[20:23], a[212:215], v[144:159]
    v_mfma_f32_32x32x16_bf16 v[144:159], a[24:27], a[216:219], v[144:159]
    v_mfma_f32_32x32x16_bf16 v[144:159], a[28:31], a[220:223], v[144:159]
    v_mfma_f32_32x32x16_bf16 v[144:159], a[68:71], a[224:227], v[144:159]
    v_mfma_f32_32x32x16_bf16 v[160:175], a[112:115], v[224:227], v[160:175]
    v_mfma_f32_32x32x16_bf16 v[160:175], a[116:119], v[228:231], v[160:175]
    v_mfma_f32_32x32x16_bf16 v[160:175], a[120:123], v[232:235], v[160:175]
    v_mfma_f32_32x32x16_bf16 v[160:175], a[124:127], v[236:239], v[160:175]
    v_mfma_f32_32x32x16_bf16 v[160:175], a[32:35], a[208:211], v[160:175]
    v_mfma_f32_32x32x16_bf16 v[160:175], a[36:39], a[212:215], v[160:175]
    v_mfma_f32_32x32x16_bf16 v[160:175], a[40:43], a[216:219], v[160:175]
    v_mfma_f32_32x32x16_bf16 v[160:175], a[44:47], a[220:223], v[160:175]
    v_mfma_f32_32x32x16_bf16 v[160:175], a[72:75], a[224:227], v[160:175]
    v_mfma_f32_32x32x16_bf16 v[176:191], a[128:131], v[224:227], v[176:191]
    v_mfma_f32_32x32x16_bf16 v[176:191], a[132:135], v[228:231], v[176:191]
    v_mfma_f32_32x32x16_bf16 v[176:191], a[136:139], v[232:235], v[176:191]
    v_mfma_f32_32x32x16_bf16 v[176:191], a[140:143], v[236:239], v[176:191]
    v_mfma_f32_32x32x16_bf16 v[176:191], a[48:51], a[208:211], v[176:191]
    v_mfma_f32_32x32x16_bf16 v[176:191], a[52:55], a[212:215], v[176:191]
    v_mfma_f32_32x32x16_bf16 v[176:191], a[56:59], a[216:219], v[176:191]
    v_mfma_f32_32x32x16_bf16 v[176:191], a[60:63], a[220:223], v[176:191]
    v_mfma_f32_32x32x16_bf16 v[176:191], a[76:79], a[224:227], v[176:191]
    v_exp_f32 v64, v128
    v_exp_f32 v65, v129
    v_exp_f32 v66, v130
    v_exp_f32 v67, v131
    v_exp_f32 v68, v132
    v_exp_f32 v69, v133
    v_exp_f32 v70, v134
    v_exp_f32 v71, v135
    v_exp_f32 v72, v136
    v_exp_f32 v73, v137
    v_exp_f32 v74, v138
    v_exp_f32 v75, v139
    v_exp_f32 v76, v140
    v_exp_f32 v77, v141
    v_exp_f32 v78, v142
    v_exp_f32 v79, v143
    v_exp_f32 v80, v144
    v_exp_f32 v81, v145
    v_exp_f32 v82, v146
    v_exp_f32 v83, v147
    v_exp_f32 v84, v148
    v_exp_f32 v85, v149
    v_exp_f32 v86, v150
    v_exp_f32 v87, v151
    v_exp_f32 v88, v152
    v_exp_f32 v89, v153
    v_exp_f32 v90, v154
    v_exp_f32 v91, v155
    v_exp_f32 v92, v156
    v_exp_f32 v93, v157
    v_exp_f32 v94, v158
    v_exp_f32 v95, v159
    v_exp_f32 v96, v160
    v_exp_f32 v97, v161
    v_exp_f32 v98, v162
    v_exp_f32 v99, v163
    v_exp_f32 v100, v164
    v_exp_f32 v101, v165
    v_exp_f32 v102, v166
    v_exp_f32 v103, v167
    v_exp_f32 v104, v168
    v_exp_f32 v105, v169
    v_exp_f32 v106, v170
    v_exp_f32 v107, v171
    v_exp_f32 v108, v172
    v_exp_f32 v109, v173
    v_exp_f32 v110, v174
    v_exp_f32 v111, v175
    v_exp_f32 v112, v176
    v_exp_f32 v113, v177
    v_exp_f32 v114, v178
    v_exp_f32 v115, v179
    v_exp_f32 v116, v180
    v_exp_f32 v117, v181
    v_exp_f32 v118, v182
    v_exp_f32 v119, v183
    v_exp_f32 v120, v184
    v_exp_f32 v121, v185
    v_exp_f32 v122, v186
    v_exp_f32 v123, v187
    v_exp_f32 v124, v188
    v_exp_f32 v125, v189
    v_exp_f32 v126, v190
    v_exp_f32 v127, v191
    v_add_f32 v64, 1.0, v64
    v_add_f32 v65, 1.0, v65
    v_add_f32 v66, 1.0, v66
    v_add_f32 v67, 1.0, v67
    v_add_f32 v68, 1.0, v68
    v_add_f32 v69, 1.0, v69
    v_add_f32 v70, 1.0, v70
    v_add_f32 v71, 1.0, v71
    v_add_f32 v72, 1.0, v72
    v_add_f32 v73, 1.0, v73
    v_add_f32 v74, 1.0, v74
    v_add_f32 v75, 1.0, v75
    v_add_f32 v76, 1.0, v76
    v_add_f32 v77, 1.0, v77
    v_add_f32 v78, 1.0, v78
    v_add_f32 v79, 1.0, v79
    v_add_f32 v80, 1.0, v80
    v_add_f32 v81, 1.0, v81
    v_add_f32 v82, 1.0, v82
    v_add_f32 v83, 1.0, v83
    v_add_f32 v84, 1.0, v84
    v_add_f32 v85, 1.0, v85
    v_add_f32 v86, 1.0, v86
    v_add_f32 v87, 1.0, v87
    v_add_f32 v88, 1.0, v88
    v_add_f32 v89, 1.0, v89
    v_add_f32 v90, 1.0, v90
    v_add_f32 v91, 1.0, v91
    v_add_f32 v92, 1.0, v92
    v_add_f32 v93, 1.0, v93
    v_add_f32 v94, 1.0, v94
    v_add_f32 v95, 1.0, v95
    v_add_f32 v96, 1.0, v96
    v_add_f32 v97, 1.0, v97
    v_add_f32 v98, 1.0, v98
    v_add_f32 v99, 1.0, v99
    v_add_f32 v100, 1.0, v100
    v_add_f32 v101, 1.0, v101
    v_add_f32 v102, 1.0, v102
    v_add_f32 v103, 1.0, v103
    v_add_f32 v104, 1.0, v104
    v_add_f32 v105, 1.0, v105
    v_add_f32 v106, 1.0, v106
    v_add_f32 v107, 1.0, v107
    v_add_f32 v108, 1.0, v108
    v_add_f32 v109, 1.0, v109
    v_add_f32 v110, 1.0, v110
    v_add_f32 v111, 1.0, v111
    v_add_f32 v112, 1.0, v112
    v_add_f32 v113, 1.0, v113
    v_add_f32 v114, 1.0, v114
    v_add_f32 v115, 1.0, v115
    v_add_f32 v116, 1.0, v116
    v_add_f32 v117, 1.0, v117
    v_add_f32 v118, 1.0, v118
    v_add_f32 v119, 1.0, v119
    v_add_f32 v120, 1.0, v120
    v_add_f32 v121, 1.0, v121
    v_add_f32 v122, 1.0, v122
    v_add_f32 v123, 1.0, v123
    v_add_f32 v124, 1.0, v124
    v_add_f32 v125, 1.0, v125
    v_add_f32 v126, 1.0, v126
    v_add_f32 v127, 1.0, v127
    v_rcp_f32 v64, v64
    v_rcp_f32 v65, v65
    v_rcp_f32 v66, v66
    v_rcp_f32 v67, v67
    v_rcp_f32 v68, v68
    v_rcp_f32 v69, v69
    v_rcp_f32 v70, v70
    v_rcp_f32 v71, v71
    v_rcp_f32 v72, v72
    v_rcp_f32 v73, v73
    v_rcp_f32 v74, v74
    v_rcp_f32 v75, v75
    v_rcp_f32 v76, v76
    v_rcp_f32 v77, v77
    v_rcp_f32 v78, v78
    v_rcp_f32 v79, v79
    v_rcp_f32 v80, v80
    v_rcp_f32 v81, v81
    v_rcp_f32 v82, v82
    v_rcp_f32 v83, v83
    v_rcp_f32 v84, v84
    v_rcp_f32 v85, v85
    v_rcp_f32 v86, v86
    v_rcp_f32 v87, v87
    v_rcp_f32 v88, v88
    v_rcp_f32 v89, v89
    v_rcp_f32 v90, v90
    v_rcp_f32 v91, v91
    v_rcp_f32 v92, v92
    v_rcp_f32 v93, v93
    v_rcp_f32 v94, v94
    v_rcp_f32 v95, v95
    v_rcp_f32 v96, v96
    v_rcp_f32 v97, v97
    v_rcp_f32 v98, v98
    v_rcp_f32 v99, v99
    v_rcp_f32 v100, v100
    v_rcp_f32 v101, v101
    v_rcp_f32 v102, v102
    v_rcp_f32 v103, v103
    v_rcp_f32 v104, v104
    v_rcp_f32 v105, v105
    v_rcp_f32 v106, v106
    v_rcp_f32 v107, v107
    v_rcp_f32 v108, v108
    v_rcp_f32 v109, v109
    v_rcp_f32 v110, v110
    v_rcp_f32 v111, v111
    v_rcp_f32 v112, v112
    v_rcp_f32 v113, v113
    v_rcp_f32 v114, v114
    v_rcp_f32 v115, v115
    v_rcp_f32 v116, v116
    v_rcp_f32 v117, v117
    v_rcp_f32 v118, v118
    v_rcp_f32 v119, v119
    v_rcp_f32 v120, v120
    v_rcp_f32 v121, v121
    v_rcp_f32 v122, v122
    v_rcp_f32 v123, v123
    v_rcp_f32 v124, v124
    v_rcp_f32 v125, v125
    v_rcp_f32 v126, v126
    v_rcp_f32 v127, v127
    v_mul_f32 v64, v64, v128
    v_mul_f32 v65, v65, v129
    v_mul_f32 v66, v66, v130
    v_mul_f32 v67, v67, v131
    v_mul_f32 v68, v68, v132
    v_mul_f32 v69, v69, v133
    v_mul_f32 v70, v70, v134
    v_mul_f32 v71, v71, v135
    v_mul_f32 v72, v72, v136
    v_mul_f32 v73, v73, v137
    v_mul_f32 v74, v74, v138
    v_mul_f32 v75, v75, v139
    v_mul_f32 v76, v76, v140
    v_mul_f32 v77, v77, v141
    v_mul_f32 v78, v78, v142
    v_mul_f32 v79, v79, v143
    v_mul_f32 v80, v80, v144
    v_mul_f32 v81, v81, v145
    v_mul_f32 v82, v82, v146
    v_mul_f32 v83, v83, v147
    v_mul_f32 v84, v84, v148
    v_mul_f32 v85, v85, v149
    v_mul_f32 v86, v86, v150
    v_mul_f32 v87, v87, v151
    v_mul_f32 v88, v88, v152
    v_mul_f32 v89, v89, v153
    v_mul_f32 v90, v90, v154
    v_mul_f32 v91, v91, v155
    v_mul_f32 v92, v92, v156
    v_mul_f32 v93, v93, v157
    v_mul_f32 v94, v94, v158
    v_mul_f32 v95, v95, v159
    v_mul_f32 v96, v96, v160
    v_mul_f32 v97, v97, v161
    v_mul_f32 v98, v98, v162
    v_mul_f32 v99, v99, v163
    v_mul_f32 v100, v100, v164
    v_mul_f32 v101, v101, v165
    v_mul_f32 v102, v102, v166
    v_mul_f32 v103, v103, v167
    v_mul_f32 v104, v104, v168
    v_mul_f32 v105, v105, v169
    v_mul_f32 v106, v106, v170
    v_mul_f32 v107, v107, v171
    v_mul_f32 v108, v108, v172
    v_mul_f32 v109, v109, v173
    v_mul_f32 v110, v110, v174
    v_mul_f32 v111, v111, v175
    v_mul_f32 v112, v112, v176
    v_mul_f32 v113, v113, v177
    v_mul_f32 v114, v114, v178
    v_mul_f32 v115, v115, v179
    v_mul_f32 v116, v116, v180
    v_mul_f32 v117, v117, v181
    v_mul_f32 v118, v118, v182
    v_mul_f32 v119, v119, v183
    v_mul_f32 v120, v120, v184
    v_mul_f32 v121, v121, v185
    v_mul_f32 v122, v122, v186
    v_mul_f32 v123, v123, v187
    v_mul_f32 v124, v124, v188
    v_mul_f32 v125, v125, v189
    v_mul_f32 v126, v126, v190
    v_mul_f32 v127, v127, v191
    v_cvt_pk_bf16_f32 v0, v64, v65
    v_cvt_pk_bf16_f32 v1, v66, v67
    v_cvt_pk_bf16_f32 v2, v68, v69
    v_cvt_pk_bf16_f32 v3, v70, v71
    v_cvt_pk_bf16_f32 v4, v72, v73
    v_cvt_pk_bf16_f32 v5, v74, v75
    v_cvt_pk_bf16_f32 v6, v76, v77
    v_cvt_pk_bf16_f32 v7, v78, v79
    v_cvt_pk_bf16_f32 v8, v80, v81
    v_cvt_pk_bf16_f32 v9, v82, v83
    v_cvt_pk_bf16_f32 v10, v84, v85
    v_cvt_pk_bf16_f32 v11, v86, v87
    v_cvt_pk_bf16_f32 v12, v88, v89
    v_cvt_pk_bf16_f32 v13, v90, v91
    v_cvt_pk_bf16_f32 v14, v92, v93
    v_cvt_pk_bf16_f32 v15, v94, v95
    v_cvt_pk_bf16_f32 v16, v96, v97
    v_cvt_pk_bf16_f32 v17, v98, v99
    v_cvt_pk_bf16_f32 v18, v100, v101
    v_cvt_pk_bf16_f32 v19, v102, v103
    v_cvt_pk_bf16_f32 v20, v104, v105
    v_cvt_pk_bf16_f32 v21, v106, v107
    v_cvt_pk_bf16_f32 v22, v108, v109
    v_cvt_pk_bf16_f32 v23, v110, v111
    v_cvt_pk_bf16_f32 v24, v112, v113
    v_cvt_pk_bf16_f32 v25, v114, v115
    v_cvt_pk_bf16_f32 v26, v116, v117
    v_cvt_pk_bf16_f32 v27, v118, v119
    v_cvt_pk_bf16_f32 v28, v120, v121
    v_cvt_pk_bf16_f32 v29, v122, v123
    v_cvt_pk_bf16_f32 v30, v124, v125
    v_cvt_pk_bf16_f32 v31, v126, v127
    v_lshlrev_b32 v247, 7, v242
    ds_read_b128 v[128:131], v247 offset:6656
    ds_read_b128 v[132:135], v247 offset:6672
    ds_read_b128 v[136:139], v247 offset:6688
    ds_read_b128 v[140:143], v247 offset:6704
    ds_read_b128 v[144:147], v247 offset:6720
    ds_read_b128 v[148:151], v247 offset:6736
    ds_read_b128 v[152:155], v247 offset:6752
    ds_read_b128 v[156:159], v247 offset:6768
    v_mfma_f32_32x32x16_bf16 v[192:207], a[144:147], v[0:3], 0
    v_mfma_f32_32x32x16_bf16 v[192:207], a[148:151], v[4:7], v[192:207]
    v_mfma_f32_32x32x16_bf16 v[192:207], a[152:155], v[8:11], v[192:207]
    v_mfma_f32_32x32x16_bf16 v[192:207], a[156:159], v[12:15], v[192:207]
    v_mfma_f32_32x32x16_bf16 v[192:207], a[160:163], v[16:19], v[192:207]
    v_mfma_f32_32x32x16_bf16 v[192:207], a[164:167], v[20:23], v[192:207]
    v_mfma_f32_32x32x16_bf16 v[192:207], a[168:171], v[24:27], v[192:207]
    v_mfma_f32_32x32x16_bf16 v[192:207], a[172:175], v[28:31], v[192:207]
    v_mfma_f32_32x32x16_bf16 v[208:223], a[176:179], v[0:3], 0
    v_mfma_f32_32x32x16_bf16 v[208:223], a[180:183], v[4:7], v[208:223]
    v_mfma_f32_32x32x16_bf16 v[208:223], a[184:187], v[8:11], v[208:223]
    v_mfma_f32_32x32x16_bf16 v[208:223], a[188:191], v[12:15], v[208:223]
    v_mfma_f32_32x32x16_bf16 v[208:223], a[192:195], v[16:19], v[208:223]
    v_mfma_f32_32x32x16_bf16 v[208:223], a[196:199], v[20:23], v[208:223]
    v_mfma_f32_32x32x16_bf16 v[208:223], a[200:203], v[24:27], v[208:223]
    v_mfma_f32_32x32x16_bf16 v[208:223], a[204:207], v[28:31], v[208:223]
    s_waitcnt lgkmcnt(0)
    s_nop 2
    v_fma_f32 v192, v192, s48, v128
    v_fma_f32 v193, v193, s48, v129
    v_fma_f32 v194, v194, s48, v130
    v_fma_f32 v195, v195, s48, v131
    v_fma_f32 v196, v196, s48, v132
    v_fma_f32 v197, v197, s48, v133
    v_fma_f32 v198, v198, s48, v134
    v_fma_f32 v199, v199, s48, v135
    v_fma_f32 v200, v200, s48, v136
    v_fma_f32 v201, v201, s48, v137
    v_fma_f32 v202, v202, s48, v138
    v_fma_f32 v203, v203, s48, v139
    v_fma_f32 v204, v204, s48, v140
    v_fma_f32 v205, v205, s48, v141
    v_fma_f32 v206, v206, s48, v142
    v_fma_f32 v207, v207, s48, v143
    v_fma_f32 v208, v208, s48, v144
    v_fma_f32 v209, v209, s48, v145
    v_fma_f32 v210, v210, s48, v146
    v_fma_f32 v211, v211, s48, v147
    v_fma_f32 v212, v212, s48, v148
    v_fma_f32 v213, v213, s48, v149
    v_fma_f32 v214, v214, s48, v150
    v_fma_f32 v215, v215, s48, v151
    v_fma_f32 v216, v216, s48, v152
    v_fma_f32 v217, v217, s48, v153
    v_fma_f32 v218, v218, s48, v154
    v_fma_f32 v219, v219, s48, v155
    v_fma_f32 v220, v220, s48, v156
    v_fma_f32 v221, v221, s48, v157
    v_fma_f32 v222, v222, s48, v158
    v_fma_f32 v223, v223, s48, v159
    ds_add_f32 v246, v192 offset:8192
    ds_add_f32 v246, v193 offset:8196
    ds_add_f32 v246, v194 offset:8200
    ds_add_f32 v246, v195 offset:8204
    ds_add_f32 v246, v196 offset:8208
    ds_add_f32 v246, v197 offset:8212
    ds_add_f32 v246, v198 offset:8216
    ds_add_f32 v246, v199 offset:8220
    ds_add_f32 v246, v200 offset:8224
    ds_add_f32 v246, v201 offset:8228
    ds_add_f32 v246, v202 offset:8232
    ds_add_f32 v246, v203 offset:8236
    ds_add_f32 v246, v204 offset:8240
    ds_add_f32 v246, v205 offset:8244
    ds_add_f32 v246, v206 offset:8248
    ds_add_f32 v246, v207 offset:8252
    ds_add_f32 v246, v208 offset:8256
    ds_add_f32 v246, v209 offset:8260
    ds_add_f32 v246, v210 offset:8264
    ds_add_f32 v246, v211 offset:8268
    ds_add_f32 v246, v212 offset:8272
    ds_add_f32 v246, v213 offset:8276
    ds_add_f32 v246, v214 offset:8280
    ds_add_f32 v246, v215 offset:8284
    ds_add_f32 v246, v216 offset:8288
    ds_add_f32 v246, v217 offset:8292
    ds_add_f32 v246, v218 offset:8296
    ds_add_f32 v246, v219 offset:8300
    ds_add_f32 v246, v220 offset:8304
    ds_add_f32 v246, v221 offset:8308
    ds_add_f32 v246, v222 offset:8312
    ds_add_f32 v246, v223 offset:8316
    s_mov_b64 exec, -1
    s_waitcnt lgkmcnt(0)
L_s_next:
    v_mov_b32 v252, v253
    v_mov_b32 v253, v254
    v_mov_b32 v254, v255
    s_add_u32 s57, s57, 4
    s_cmp_lt_u32 s57, 16
    s_cbranch_scc1 L_s_sub
    s_add_u32 s56, s56, 2048
    s_cmp_lt_u32 s56, 3200000
    s_cbranch_scc1 L_s_blk
    s_barrier
    s_lshl_b32 s3, s31, 1
    v_add_u32 v1, s3, v242
L_s_out:
    v_cmp_gt_u32 vcc, s30, v1
    v_mul_u32_u24 v4, 260, v1
    v_lshl_add_u32 v4, v241, 3, v4
    v_add_u32 v4, 8192, v4
    v_add_u32 v5, s29, v1
    v_lshlrev_b32 v5, 7, v5
    v_lshl_add_u32 v5, v241, 2, v5
    s_and_b64 exec, exec, vcc
    s_cbranch_execz L_s_end
    ds_read2_b32 v[2:3], v4 offset0:0 offset1:1
    s_waitcnt lgkmcnt(0)
    v_cvt_pk_bf16_f32 v2, v2, v3
    buffer_store_dword v2, v5, s[24:27], 0 offen
    v_add_u32 v1, 8, v1
    s_branch L_s_out
L_s_end:
    s_endpgm
.p2align 7
.type L_table,@object
L_table:
.long 0x60800040, 0x800040, 0x840040, 0x880040, 0x10800040, 0x10840040, 0x10880040, 0x108c0040
.long 0x10900040, 0x10940040, 0x10980040, 0x109c0040, 0x10a00040, 0x10a40040, 0x10a80040, 0x70800040
.long 0x70840040, 0x70880040, 0x708c0040, 0x70900040, 0x70940040, 0x70980040, 0x709c0040, 0x70a00040
.long 0x70a40040, 0x70a80040, 0x40800080, 0x40840080, 0x40880080, 0x408c0080, 0x40900080, 0x40940080
.long 0x40980080, 0x409c0080, 0x40a00080, 0x40a40080, 0x40a80080, 0x40ac0080, 0x40b00080, 0x40b40080
.long 0x40b80080, 0x40bc0080, 0x40c00080, 0x40c40080, 0x40c80080, 0x40cc0080, 0x40d00080, 0x40d40080
.long 0x40d80080, 0x40dc0080, 0x40e00080, 0x40e40080, 0x40e80080, 0x40ec0080, 0x40f00080, 0x40f40080
.long 0x40f80080, 0x40fc0080, 0x30800040, 0x30840040, 0x30880040, 0x308c0040, 0x30900040, 0x30940040
.long 0x30980040, 0x309c0040, 0x30a00040, 0x30a40040, 0x30a80040, 0x30ac0040, 0x30b00040, 0x20800080
.long 0x20840080, 0x20880080, 0x208c0080, 0x20900080, 0x20940080, 0x20980080, 0x209c0080, 0x20a00080
.long 0x20a40080, 0x20a80080, 0x20ac0080, 0x20b00080, 0x20b40080, 0x20b80080, 0x20bc0080, 0x20c00080
.long 0x20c40080, 0x20c80080, 0x20cc0080, 0x20d00080, 0x20d40080, 0x20d80080, 0x20dc0080, 0x20e00080
.long 0x20e40080, 0x20e80080, 0x20ec0080, 0x20f00080, 0x20f40080, 0x20f80080, 0x20fc0080, 0x60840080
.long 0x60880080, 0x608c0080, 0x60900080, 0x60940080, 0x60980080, 0x609c0080, 0x60a00080, 0x60a40080
.long 0x60a80080, 0x60ac0080, 0x60b00080, 0x60b40080, 0x60b80080, 0x60bc0080, 0x60c40080, 0x60c80080
.long 0x60cc0080, 0x60d00080, 0x60d40080, 0x60d80080, 0x60dc0080, 0x60e00080, 0x60e40080, 0x60e80080
.long 0x60ec0080, 0x60f00080, 0x60f40080, 0x60f80080, 0x60fc0080, 0x8c0080, 0x900080, 0x940080
.long 0x980080, 0x9c0080, 0xa00080, 0xa40080, 0xa80080, 0xac0080, 0xb00080, 0xb40080
.long 0xb80080, 0xbc0080, 0xcc0080, 0xd00080, 0xd40080, 0xd80080, 0xdc0080, 0xe00080
.long 0xe40080, 0xe80080, 0xec0080, 0xf00080, 0xf40080, 0xf80080, 0xfc0080, 0x10ac0080
.long 0x10b00080, 0x10b40080, 0x10b80080, 0x10bc0080, 0x10ec0080, 0x10f00080, 0x10f40080, 0x10f80080
.long 0x10fc0080, 0x50800040, 0x50840040, 0x50880040, 0x508c0040, 0x50900040, 0x50940040, 0x50980040
.long 0x509c0040, 0x50a00040, 0x50a40040, 0x50a80040, 0x50ac0040, 0x50b00040, 0x50b40040, 0x50b80040
.long 0x50bc0040, 0x70ac0080, 0x70b00080, 0x70b40080, 0x70b80080, 0x70bc0080, 0x70ec0080, 0x70f00080
.long 0x70f40080, 0x70f80080, 0x70fc0080, 0x30b40080, 0x30b80080, 0x30bc0080, 0x30f40080, 0x30f80080
.long 0x30fc0080, 0x80, 0x80, 0x80, 0x80, 0x80, 0x80, 0x80
.long 0x80, 0x80, 0x80, 0x80, 0x80, 0x80, 0x80, 0x80
.long 0x80, 0x80, 0x80, 0x80, 0x80, 0x80, 0x80, 0x80
.long 0x80, 0x80, 0x80, 0x80, 0x80, 0x80, 0x80, 0x80
.long 0x80, 0x80, 0x80, 0x80, 0x80, 0x80, 0x80, 0x80
.long 0x80, 0x80, 0x80, 0x80, 0x80, 0x80, 0x80, 0x80
.long 0x80, 0x80, 0x80, 0x80, 0x80, 0x80, 0x80, 0x80
.long 0x40800040, 0x800040, 0x840040, 0x20800040, 0x20840040, 0x20880040, 0x208c0040, 0x20900040
.long 0x20940040, 0x30800040, 0x30840040, 0x30880040, 0x308c0040, 0x30900040, 0x30940040, 0x30980040
.long 0x309c0040, 0x30a00040, 0x30a40040, 0x30a80040, 0x30ac0040, 0x30b00040, 0x30b40040, 0x30b80040
.long 0x10800040, 0x10840040, 0x10880040, 0x108c0040, 0x10900040, 0x10940040, 0x10980040, 0x109c0040
.long 0x10a00040, 0x10a40040, 0x10a80040, 0x60800080, 0x60840080, 0x60880080, 0x608c0080, 0x60900080
.long 0x60940080, 0x60980080, 0x609c0080, 0x60a00080, 0x60a40080, 0x60a80080, 0x60ac0080, 0x60b00080
.long 0x60b40080, 0x60b80080, 0x60bc0080, 0x60c00080, 0x60c40080, 0x60c80080, 0x60cc0080, 0x60d00080
.long 0x60d40080, 0x60d80080, 0x60dc0080, 0x60e00080, 0x60e40080, 0x60e80080, 0x60ec0080, 0x60f00080
.long 0x60f40080, 0x60f80080, 0x60fc0080, 0x40840080, 0x40880080, 0x408c0080, 0x40900080, 0x40940080
.long 0x40980080, 0x409c0080, 0x40a00080, 0x40a40080, 0x40a80080, 0x40ac0080, 0x40b00080, 0x40b40080
.long 0x40b80080, 0x40bc0080, 0x40c40080, 0x40c80080, 0x40cc0080, 0x40d00080, 0x40d40080, 0x40d80080
.long 0x40dc0080, 0x40e00080, 0x40e40080, 0x40e80080, 0x40ec0080, 0x40f00080, 0x40f40080, 0x40f80080
.long 0x40fc0080, 0x50800040, 0x50840040, 0x50880040, 0x508c0040, 0x50900040, 0x50940040, 0x50980040
.long 0x509c0040, 0x50a00040, 0x50a40040, 0x50a80040, 0x50ac0040, 0x50b00040, 0x50b40040, 0x50b80040
.long 0x880080, 0x8c0080, 0x900080, 0x940080, 0x980080, 0x9c0080, 0xa00080, 0xa40080
.long 0xa80080, 0xac0080, 0xb00080, 0xb40080, 0xb80080, 0xbc0080, 0xc80080, 0xcc0080
.long 0xd00080, 0xd40080, 0xd80080, 0xdc0080, 0xe00080, 0xe40080, 0xe80080, 0xec0080
.long 0xf00080, 0xf40080, 0xf80080, 0xfc0080, 0x20980080, 0x209c0080, 0x20a00080, 0x20a40080
.long 0x20a80080, 0x20ac0080, 0x20b00080, 0x20b40080, 0x20b80080, 0x20bc0080, 0x20d80080, 0x20dc0080
.long 0x20e00080, 0x20e40080, 0x20e80080, 0x20ec0080, 0x20f00080, 0x20f40080, 0x20f80080, 0x20fc0080
.long 0x70800040, 0x70840040, 0x70880040, 0x708c0040, 0x70900040, 0x70940040, 0x70980040, 0x709c0040
.long 0x70a00040, 0x70a40040, 0x70a80040, 0x70ac0040, 0x70b00040, 0x70b40040, 0x70b80040, 0x70bc0040
.long 0x30bc0080, 0x30fc0080, 0x10ac0080, 0x10b00080, 0x10b40080, 0x10b80080, 0x10bc0080, 0x10ec0080
.long 0x10f00080, 0x10f40080, 0x10f80080, 0x10fc0080, 0x50bc0080, 0x50fc0080, 0x80, 0x80
.long 0x80, 0x80, 0x80, 0x80, 0x80, 0x80, 0x80, 0x80
.long 0x80, 0x80, 0x80, 0x80, 0x80, 0x80, 0x80, 0x80
.long 0x80, 0x80, 0x80, 0x80, 0x80, 0x80, 0x80, 0x80
.long 0x80, 0x80, 0x80, 0x80, 0x80, 0x80, 0x80, 0x80
.long 0x80, 0x80, 0x80, 0x80, 0x80, 0x80, 0x80, 0x80
.long 0x80, 0x80, 0x80, 0x80, 0x80, 0x80, 0x80, 0x80
.long 0x80, 0x80, 0x80, 0x80, 0x80, 0x80, 0x80, 0x80
.long 0x80, 0x80, 0x80, 0x80, 0x80, 0x80, 0x80, 0x80
.size L_table, 2048
.section .rodata,"a"
.p2align 6
.amdhsa_kernel standalone__edge_featured_mpnn_mpnn__graph_kernel
  .amdhsa_next_free_vgpr 512
  .amdhsa_next_free_sgpr 102
  .amdhsa_accum_offset 256
  .amdhsa_group_segment_fixed_size 0
  .amdhsa_kernarg_size 88
  .amdhsa_user_sgpr_count 2
  .amdhsa_user_sgpr_kernarg_segment_ptr 1
  .amdhsa_system_sgpr_workgroup_id_x 1
.end_amdhsa_kernel
```
